```python
import torch

def _softmax(x, axis=-1):
    return torch.softmax(x, dim=axis)
def _gelu(x):
    return torch.nn.functional.gelu(x, approximate="tanh")
def _silu(x):
    return torch.nn.functional.silu(x)
def _sigmoid(x):
    return torch.sigmoid(x)
def _layernorm(x, axis=-1, eps=1e-5):
    m = x.mean(dim=axis, keepdim=True)
    v = x.var(dim=axis, keepdim=True, unbiased=False)
    return (x - m) / torch.sqrt(v + eps)
def _scatter_add(tgt, idx, src, axis=0):
    return tgt.clone().index_add_(axis, idx, src)
def _segment_sum(src, seg, n):
    out = torch.zeros((n,) + src.shape[1:], dtype=src.dtype)
    return out.index_add_(0, seg, src)
def _pad(x, pw):
    flat = tuple(v for pair in reversed(pw) for v in pair)
    return torch.nn.functional.pad(x, flat)

kernel_name = 'parallel_sum__sliding_local_dilated__moe_arch_mod__prompt'

def setup_inputs():

    _w = (lambda a: (lambda t: t.to(torch.bfloat16) if t.is_floating_point() else t)(torch.as_tensor(a)))
    def _A_setup():
        B, S, D = 1, 2048, 640
        return {
            "x": _w((lambda *s: torch.randn(*s, dtype=torch.bfloat16) * 0.05)(B, S, D)),
            "wqkv": _w((lambda *s: torch.randn(*s, dtype=torch.bfloat16) * 0.05)(D, 3 * D)),
            "wo": _w((lambda *s: torch.randn(*s, dtype=torch.bfloat16) * 0.05)(D, D)),
        }
    _A_in = _A_setup()

    def _B_setup():
        B, S, D, F, C = 1, 2048, 640, 1536, 2
        return {
            "x": _w((lambda *s: torch.randn(*s, dtype=torch.bfloat16) * 0.05)(B, S, D)),
            "w_r": _w((lambda *s: torch.randn(*s, dtype=torch.bfloat16) * 0.05)(D)),
            "w_gate": _w((lambda *s: torch.randn(*s, dtype=torch.bfloat16) * 0.05)(D, F)),
            "w_up": _w((lambda *s: torch.randn(*s, dtype=torch.bfloat16) * 0.05)(D, F)),
            "w_down": _w((lambda *s: torch.randn(*s, dtype=torch.bfloat16) * 0.05)(F, D)),
        }
    _B_in = _B_setup()

    return {
        "A_x": _A_in["x"],
        "A_wqkv": _A_in["wqkv"],
        "A_wo": _A_in["wo"],
        "B_x": _B_in["x"],
        "B_w_r": _B_in["w_r"],
        "B_w_gate": _B_in["w_gate"],
        "B_w_up": _B_in["w_up"],
        "B_w_down": _B_in["w_down"],
    }

def reference(A_x, A_wqkv, A_wo, B_x, B_w_r, B_w_gate, B_w_up, B_w_down):
    def _A_ref(x, wqkv, wo):
        B, S, D = x.shape
        H = 32; Dh = D // H
        W, dil = 8, 2
        qkv = (lambda x, *d: x.permute(*d))((x @ wqkv).reshape(B, S, 3, H, Dh), 2, 0, 3, 1, 4)
        q, k, v = qkv[0], qkv[1], qkv[2]
        scale = Dh ** -0.5
        pos = torch.arange(S)
        off = torch.arange(W) * dil
        idx = pos[:, None] - off[None, :]
        mask = idx >= 0
        idx_c = torch.where(mask, idx, 0).reshape(-1)
        kg = k[:, :, idx_c, :].reshape(B, H, S, W, Dh)
        vg = v[:, :, idx_c, :].reshape(B, H, S, W, Dh)
        logits = torch.einsum("bhsd,bhswd->bhsw", q, kg) * scale
        logits = torch.where(mask[None, None, :, :], logits, -1e9)
        attn = _softmax(logits, axis=-1)
        o = torch.einsum("bhsw,bhswd->bhsd", attn, vg)
        return (lambda x, *d: x.permute(*d))(o, 0, 2, 1, 3).reshape(B, S, D) @ wo

    def _B_ref(x, w_r, w_gate, w_up, w_down):
        B, S, D = x.shape
        C = 2
        r = x @ w_r
        idx = torch.argsort(-r, axis=-1)[:, :C]
        idx_e = (lambda x, n, axis: torch.repeat_interleave(x, n, dim=axis))(idx.reshape(B, C, 1), D, axis=2)
        x_sel = (lambda x, i, axis: torch.take_along_dim(x, i, dim=axis))(x, idx_e, axis=1)
        g = _silu(x_sel @ w_gate)
        u = x_sel @ w_up
        y = (g * u) @ w_down
        r_sel = _sigmoid((lambda x, i, axis: torch.take_along_dim(x, i, dim=axis))(r, idx, axis=1))
        y = y * r_sel.reshape(B, C, 1)
        b_off = (torch.arange(B) * S).reshape(B, 1)
        flat_idx = (idx + b_off).reshape(B * C)
        zero = (x * 0.0).reshape(B * S, D)
        upd = _scatter_add(zero, flat_idx, y.reshape(B * C, D), axis=0)
        return x + upd.reshape(B, S, D)

    x = A_x
    xn = _layernorm(x, axis=-1)
    return x + _A_ref(xn, A_wqkv, A_wo) + _B_ref(xn, B_w_r, B_w_gate, B_w_up, B_w_down)
```

```asm
; @launch grid=(256,1,1) block=(512,1,1) lds=163840
.amdgcn_target "amdgcn-amd-amdhsa--gfx950"
.text
.globl parallel_sum__sliding_local_dilated__moe_arch_mod__prompt_kernel
.p2align 8
.type parallel_sum__sliding_local_dilated__moe_arch_mod__prompt_kernel,@function
parallel_sum__sliding_local_dilated__moe_arch_mod__prompt_kernel:
    s_load_dwordx16 s[16:31], s[0:1], 0
    s_load_dwordx4 s[32:35], s[0:1], 64
    s_load_dwordx2 s[36:37], s[0:1], 80
    s_cmp_ge_u32 s2, 256
    s_cbranch_scc1 L_end
    v_lshrrev_b32 v1, 6, v0
    v_and_b32 v0, 63, v0
    s_lshr_b32 s4, s2, 3
    v_readfirstlane_b32 s5, v1
    s_and_b32 s3, s2, 7
    s_cmp_lg_u32 s5, 3
    s_cbranch_scc1 L_nopf
    s_getpc_b64 s[12:13]
L_pc:
    s_and_b32 s14, s4, 3
    s_lshl_b32 s14, s14, 13
    v_lshl_add_u32 v2, v0, 7, s14
    v_min_u32 v2, 0x6cd8, v2
    global_load_dword v255, v2, s[12:13]
L_nopf:
    s_bfe_u32 s76, s2, 0x10001
    s_and_b32 s77, s2, 1
    s_bfe_u32 s78, s2, 0x10002
    s_mul_i32 s11, s4, 52
    s_lshr_b32 s11, s11, 8
    s_mul_i32 s12, s11, 5
    s_sub_u32 s7, s4, s12
    s_mul_i32 s12, s78, 11
    s_add_u32 s6, s11, s12
    s_mul_i32 s12, s76, 6
    s_add_u32 s6, s6, s12
    s_mul_i32 s12, s77, 5
    s_add_u32 s8, s7, s12
    s_mul_i32 s12, s76, 5
    s_sub_u32 s12, 30, s12
    s_sub_u32 s79, s4, s12
    s_cmp_ge_u32 s4, s12
    s_cbranch_scc1 L_aux
    s_cmp_ge_u32 s5, 4
    s_cbranch_scc1 L_loader
    s_mul_i32 s12, s5, 10
    s_add_u32 s12, s12, s8
    s_cmp_ge_u32 s12, 24
    s_cbranch_scc1 L_w23
    s_mul_i32 s11, s6, 96
    s_lshl_b32 s12, s12, 2
    s_add_u32 s11, s11, s12
L_stats:
    s_setprio 3
    v_lshrrev_b32 v2, 4, v0
    v_add_u32 v2, s11, v2
    v_and_b32 v3, 15, v0
    v_lshlrev_b32 v4, 4, v3
    v_mul_u32_u24 v5, 1280, v2
    v_add_u32 v5, v5, v4
    s_waitcnt lgkmcnt(0)
    global_load_dwordx4 v[40:43], v4, s[24:25] offset:0
    global_load_dwordx4 v[44:47], v4, s[24:25] offset:256
    global_load_dwordx4 v[48:51], v4, s[24:25] offset:512
    global_load_dwordx4 v[52:55], v4, s[24:25] offset:768
    global_load_dwordx4 v[56:59], v4, s[24:25] offset:1024
    s_mov_b32 s40, s16
    s_mov_b32 s41, s17
    s_mov_b32 s42, 2621440
    s_mov_b32 s43, 0x20000
    buffer_load_dwordx4 v[20:23], v5, s[40:43], 0 offen offset:0
    buffer_load_dwordx4 v[24:27], v5, s[40:43], 0 offen offset:256
    buffer_load_dwordx4 v[28:31], v5, s[40:43], 0 offen offset:512
    buffer_load_dwordx4 v[32:35], v5, s[40:43], 0 offen offset:768
    buffer_load_dwordx4 v[36:39], v5, s[40:43], 0 offen offset:1024
    s_branch L_stats2
L_loader:
    s_sub_u32 s14, s5, 4
    s_and_b32 s15, s14, 1
    v_lshrrev_b32 v2, 3, v0
    v_and_b32 v3, 7, v0
    v_lshrrev_b32 v4, 4, v0
    s_lshl_b32 s11, s15, 2
    v_add_u32 v5, s11, v4
    v_xor_b32 v5, v3, v5
    s_mul_i32 s11, s6, 96
    s_lshl_b32 s12, s14, 3
    s_add_u32 s11, s11, s12
    s_sub_u32 s11, s11, 16
    s_mul_i32 s11, s11, 1280
    v_mul_u32_u24 v6, 1280, v2
    v_lshl_add_u32 v6, v5, 4, v6
    v_add_u32 v10, s11, v6
    v_add_u32 v11, 40960, v10
    v_add_u32 v12, 0x14000, v10
    v_add_u32 v13, 0x1e000, v10
    v_and_b32 v4, 1, v4
    v_lshl_or_b32 v4, s15, 1, v4
    v_lshlrev_b32 v4, 1, v4
    v_xor_b32 v4, v3, v4
    v_add_u32 v2, s12, v2
    v_mul_u32_u24 v2, 3840, v2
    v_lshl_add_u32 v2, v4, 4, v2
    s_lshl_b32 s11, s8, 7
    v_add_u32 v14, s11, v2
    s_mul_i32 s68, s7, 1
    s_mul_i32 s11, s6, 1
    s_add_u32 s68, s68, s11
    s_mul_i32 s11, s68, 21846
    s_lshr_b32 s11, s11, 16
    s_mul_i32 s11, s11, 3
    s_sub_u32 s68, s68, s11
    s_mul_i32 s68, s68, 7
    s_lshr_b32 s68, s68, 1
    s_lshl_b32 s69, s14, 10
    s_cmp_eq_u32 s14, 0
    s_cselect_b32 s72, 0xffff0000, -1
    s_mov_b32 s73, -1
    s_waitcnt lgkmcnt(0)
    s_mov_b32 s40, s16
    s_mov_b32 s41, s17
    s_mov_b32 s42, 2621440
    s_mov_b32 s43, 0x20000
    s_mov_b32 s44, s18
    s_mov_b32 s45, s19
    s_mov_b32 s46, 2457600
    s_mov_b32 s47, 0x20000
    s_lshl_b32 s11, s68, 7
    s_mul_i32 s39, s68, 245760
    s_add_u32 m0, s69, 38912
    s_mov_b64 exec, s[72:73]
    buffer_load_dwordx4 v10, s[40:43], s11 offen lds
    s_mov_b64 exec, -1
    s_add_u32 m0, s69, 43008
    s_nop 0
    buffer_load_dwordx4 v11, s[40:43], s11 offen lds
    s_add_u32 m0, s69, 47104
    s_nop 0
    buffer_load_dwordx4 v12, s[40:43], s11 offen lds
    s_cmp_ge_u32 s14, 2
    s_cbranch_scc1 L_xs_1
    s_add_u32 m0, s69, 51200
    s_nop 0
    buffer_load_dwordx4 v13, s[40:43], s11 offen lds
L_xs_1:
    s_add_u32 s68, s68, 1
    s_cmp_eq_u32 s68, 10
    s_cselect_b32 s68, 0, s68
    s_add_u32 m0, s69, 53248
    s_add_u32 s13, s39, 0
    buffer_load_dwordx4 v14, s[44:47], s13 offen lds
    s_add_u32 m0, s69, 61440
    s_add_u32 s13, s39, 1280
    buffer_load_dwordx4 v14, s[44:47], s13 offen lds
    s_add_u32 m0, s69, 69632
    s_add_u32 s13, s39, 2560
    buffer_load_dwordx4 v14, s[44:47], s13 offen lds
    s_add_u32 m0, s69, 57344
    s_add_u32 s13, s39, 122880
    buffer_load_dwordx4 v14, s[44:47], s13 offen lds
    s_add_u32 m0, s69, 65536
    s_add_u32 s13, s39, 124160
    buffer_load_dwordx4 v14, s[44:47], s13 offen lds
    s_add_u32 m0, s69, 73728
    s_add_u32 s13, s39, 125440
    buffer_load_dwordx4 v14, s[44:47], s13 offen lds
    s_branch L_loader2
L_aux:
    s_cmp_ge_u32 s79, 4
    s_cbranch_scc1 L_idle
    s_mul_i32 s68, s78, 12
    s_add_u32 s68, s68, s79
    s_lshl_b32 s11, s77, 1
    s_lshl_b32 s11, s11, s76
    s_add_u32 s68, s68, s11
    s_lshl_b32 s11, s76, 2
    s_add_u32 s68, s68, s11
    s_and_b32 s14, s5, 1
    s_lshr_b32 s69, s5, 1
    v_lshrrev_b32 v2, 3, v0
    v_and_b32 v3, 7, v0
    v_bfe_u32 v4, v0, 4, 1
    v_lshl_or_b32 v4, s14, 1, v4
    v_lshlrev_b32 v4, 1, v4
    v_xor_b32 v4, v3, v4
    s_and_b32 s12, s68, 1
    s_mul_i32 s12, s12, 320
    s_lshl_b32 s11, s14, 3
    s_add_u32 s11, s11, s12
    v_add_u32 v2, s11, v2
    v_mul_u32_u24 v2, 3072, v2
    v_lshl_add_u32 v2, v4, 4, v2
    s_and_b32 s11, s68, 30
    s_and_b32 s12, s69, 1
    s_add_u32 s11, s11, s12
    s_lshl_b32 s11, s11, 7
    v_add_u32 v10, s11, v2
    s_lshl_b32 s74, s69, 13
    s_lshl_b32 s11, s14, 10
    s_add_u32 s75, s74, s11
    s_waitcnt lgkmcnt(0)
    s_cmp_lt_u32 s5, 4
    s_cselect_b32 s44, s26, s28
    s_cselect_b32 s45, s27, s29
    s_mov_b32 s46, 1966080
    s_mov_b32 s47, 0x20000
    s_add_u32 m0, s75, 0
    s_mov_b32 s12, 0
    buffer_load_dwordx4 v10, s[44:47], s12 offen nt lds
    s_add_u32 m0, s75, 2048
    s_mov_b32 s12, 49152
    buffer_load_dwordx4 v10, s[44:47], s12 offen nt lds
    s_add_u32 m0, s75, 4096
    s_mov_b32 s12, 98304
    buffer_load_dwordx4 v10, s[44:47], s12 offen nt lds
    s_add_u32 m0, s75, 6144
    s_mov_b32 s12, 147456
    buffer_load_dwordx4 v10, s[44:47], s12 offen nt lds
    s_branch L_expert2
L_idle:
    s_lshl_b32 s68, s78, 1
    s_add_u32 s68, s68, s77
    s_mul_i32 s68, s68, 3
    s_add_u32 s68, s68, s79
    s_sub_u32 s68, s68, 4
    s_mul_i32 s72, s5, 5120
    s_mul_i32 s73, s68, 163840
    s_add_u32 s73, s73, s72
    s_bfe_u32 s11, s5, 0x10001
    s_lshl_b32 s11, s11, 2
    v_add_u32 v2, 0, v0
    v_mul_u32_u24 v3, 820, v2
    v_lshrrev_b32 v3, 16, v3
    v_mul_u32_u24 v4, 80, v3
    v_sub_u32 v4, v2, v4
    v_or_b32 v5, s11, v3
    v_lshlrev_b32 v5, 1, v5
    v_xor_b32 v4, v4, v5
    v_mul_u32_u24 v3, 1280, v3
    v_lshl_add_u32 v26, v4, 4, v3
    v_add_u32 v2, 64, v0
    v_mul_u32_u24 v3, 820, v2
    v_lshrrev_b32 v3, 16, v3
    v_mul_u32_u24 v4, 80, v3
    v_sub_u32 v4, v2, v4
    v_or_b32 v5, s11, v3
    v_lshlrev_b32 v5, 1, v5
    v_xor_b32 v4, v4, v5
    v_mul_u32_u24 v3, 1280, v3
    v_lshl_add_u32 v27, v4, 4, v3
    v_add_u32 v2, 128, v0
    v_mul_u32_u24 v3, 820, v2
    v_lshrrev_b32 v3, 16, v3
    v_mul_u32_u24 v4, 80, v3
    v_sub_u32 v4, v2, v4
    v_or_b32 v5, s11, v3
    v_lshlrev_b32 v5, 1, v5
    v_xor_b32 v4, v4, v5
    v_mul_u32_u24 v3, 1280, v3
    v_lshl_add_u32 v28, v4, 4, v3
    v_add_u32 v2, 192, v0
    v_mul_u32_u24 v3, 820, v2
    v_lshrrev_b32 v3, 16, v3
    v_mul_u32_u24 v4, 80, v3
    v_sub_u32 v4, v2, v4
    v_or_b32 v5, s11, v3
    v_lshlrev_b32 v5, 1, v5
    v_xor_b32 v4, v4, v5
    v_mul_u32_u24 v3, 1280, v3
    v_lshl_add_u32 v29, v4, 4, v3
    v_add_u32 v2, 256, v0
    v_mul_u32_u24 v3, 820, v2
    v_lshrrev_b32 v3, 16, v3
    v_mul_u32_u24 v4, 80, v3
    v_sub_u32 v4, v2, v4
    v_or_b32 v5, s11, v3
    v_lshlrev_b32 v5, 1, v5
    v_xor_b32 v4, v4, v5
    v_mul_u32_u24 v3, 1280, v3
    v_lshl_add_u32 v30, v4, 4, v3
    s_waitcnt lgkmcnt(0)
    s_mov_b32 s64, s30
    s_mov_b32 s65, s31
    s_mov_b32 s66, 1966080
    s_mov_b32 s67, 0x20000
    s_add_u32 m0, s72, 0
    s_add_u32 s12, s73, 0
    buffer_load_dwordx4 v26, s[64:67], s12 offen nt lds
    s_add_u32 m0, s72, 1024
    s_add_u32 s12, s73, 0
    buffer_load_dwordx4 v27, s[64:67], s12 offen nt lds
    s_add_u32 m0, s72, 2048
    s_add_u32 s12, s73, 0
    buffer_load_dwordx4 v28, s[64:67], s12 offen nt lds
    s_add_u32 m0, s72, 3072
    s_add_u32 s12, s73, 0
    buffer_load_dwordx4 v29, s[64:67], s12 offen nt lds
    s_add_u32 m0, s72, 4096
    s_add_u32 s12, s73, 0
    buffer_load_dwordx4 v30, s[64:67], s12 offen nt lds
    s_branch L_down2
L_loader2:
    s_load_dword s10, s[36:37], 0
    s_mov_b32 s52, s36
    s_mov_b32 s53, s37
    s_mov_b32 s54, 11534336
    s_mov_b32 s55, 0x20000
    s_mov_b32 s48, s20
    s_mov_b32 s49, s21
    s_mov_b32 s50, 819200
    s_mov_b32 s51, 0x20000
    s_lshr_b32 s11, s4, 2
    s_mul_i32 s11, s11, 160
    s_and_b32 s70, s4, 1
    s_mul_i32 s70, s70, 10
    v_add_u32 v2, 0, v0
    v_mul_u32_u24 v3, 6554, v2
    v_lshrrev_b32 v3, 16, v3
    v_mul_u32_u24 v4, 10, v3
    v_sub_u32 v4, v2, v4
    v_mul_u32_u24 v3, 1280, v3
    v_lshl_add_u32 v3, v4, 4, v3
    v_add_u32 v20, s11, v3
    v_add_u32 v2, 64, v0
    v_mul_u32_u24 v3, 6554, v2
    v_lshrrev_b32 v3, 16, v3
    v_mul_u32_u24 v4, 10, v3
    v_sub_u32 v4, v2, v4
    v_mul_u32_u24 v3, 1280, v3
    v_lshl_add_u32 v3, v4, 4, v3
    v_add_u32 v21, s11, v3
    v_add_u32 v2, 128, v0
    v_mul_u32_u24 v3, 6554, v2
    v_lshrrev_b32 v3, 16, v3
    v_mul_u32_u24 v4, 10, v3
    v_sub_u32 v4, v2, v4
    v_mul_u32_u24 v3, 1280, v3
    v_lshl_add_u32 v3, v4, 4, v3
    v_add_u32 v22, s11, v3
    v_add_u32 v2, 192, v0
    v_mul_u32_u24 v3, 6554, v2
    v_lshrrev_b32 v3, 16, v3
    v_mul_u32_u24 v4, 10, v3
    v_sub_u32 v4, v2, v4
    v_mul_u32_u24 v3, 1280, v3
    v_lshl_add_u32 v3, v4, 4, v3
    v_add_u32 v23, s11, v3
    v_add_u32 v2, 256, v0
    v_mul_u32_u24 v3, 6554, v2
    v_lshrrev_b32 v3, 16, v3
    v_mul_u32_u24 v4, 10, v3
    v_sub_u32 v4, v2, v4
    v_mul_u32_u24 v3, 1280, v3
    v_lshl_add_u32 v3, v4, 4, v3
    v_add_u32 v24, s11, v3
    s_mul_i32 s11, s6, 96
    s_lshl_b32 s12, s14, 6
    s_add_u32 s11, s11, s12
    s_sub_u32 s11, s11, 16
    v_add_u32 v26, s11, v0
    v_lshlrev_b32 v27, 3, v26
    v_add_u32 v27, 4096, v27
    v_add_u32 v28, s12, v0
    v_and_b32 v100, 15, v0
    v_lshrrev_b32 v101, 4, v0
    s_lshl_b32 s11, s5, 4
    v_add_u32 v102, s11, v100
    v_mul_u32_u24 v102, 496, v102
    v_lshlrev_b32 v103, 3, v101
    v_mov_b32 v104, 0x08100800
    v_lshrrev_b32 v103, v103, v104
    v_and_b32 v103, 0xff, v103
    v_add_u32 v231, v102, v103
    v_add_u32 v228, 7936, v231
    v_lshrrev_b32 v102, 2, v0
    v_add_u32 v102, s11, v102
    v_mul_u32_u24 v102, 496, v102
    v_and_b32 v103, 3, v0
    v_lshl_add_u32 v229, v103, 3, v102
    v_and_b32 v102, 1, v0
    v_lshl_add_u32 v103, v101, 2, v102
    v_lshlrev_b32 v102, 4, v102
    v_mov_b32 v104, 0xffff
    v_lshlrev_b32 v104, v102, v104
    v_cmp_le_u32 vcc, v103, v100
    s_nop 1
    v_cndmask_b32 v212, 0, v104, vcc
    v_xor_b32 v214, v212, v104
    v_add_u32 v103, 2, v103
    v_cmp_le_u32 vcc, v103, v100
    s_nop 1
    v_cndmask_b32 v213, 0, v104, vcc
    v_xor_b32 v215, v213, v104
    v_mov_b32 v196, 0
    v_mov_b32 v197, 0
    v_mov_b32 v198, 0
    v_mov_b32 v199, 0
    v_mov_b32 v200, 0
    v_mov_b32 v201, 0
    v_mov_b32 v202, 0
    v_mov_b32 v203, 0
    v_mov_b32 v204, 0
    v_mov_b32 v205, 0
    v_mov_b32 v206, 0
    v_mov_b32 v207, 0
    v_mov_b32 v208, 0
    v_mov_b32 v209, 0
    v_mov_b32 v210, 0
    v_mov_b32 v211, 0
    s_lshl_b32 s60, s3, 2
    s_and_b32 s11, s4, 3
    s_add_u32 s60, s60, s11
    s_lshl_b32 s60, s60, 2
    s_and_b32 s12, s5, 3
    s_add_u32 s60, s60, s12
    s_lshr_b32 s61, s5, 2
    s_xor_b32 s61, s61, s3
    s_and_b32 s61, s61, 1
    s_lshr_b32 s62, s4, 2
    s_mul_i32 s62, s62, 80
    s_mov_b32 s38, 0
    v_and_b32 v100, 15, v0
    v_lshrrev_b32 v101, 4, v0
    s_lshl_b32 s12, s60, 4
    v_add_u32 v102, s12, v100
    v_lshlrev_b32 v235, 3, v102
    v_add_u32 v235, 4096, v235
    v_mul_u32_u24 v102, 1280, v102
    v_lshl_add_u32 v102, v101, 3, v102
    s_lshl_b32 s12, s62, 1
    v_add_u32 v234, s12, v102
    v_lshlrev_b32 v254, 4, v0
    v_and_b32 v102, 1, v101
    v_mul_u32_u24 v102, 24, v102
    v_add_u32 v233, v234, v102
    v_lshrrev_b32 v102, 2, v0
    v_and_b32 v103, 3, v0
    v_mul_u32_u24 v102, 160, v102
    v_lshl_add_u32 v102, v103, 3, v102
    s_xor_b32 s12, s61, s11
    s_and_b32 s12, s12, 1
    s_mul_i32 s12, s12, 51200
    s_add_u32 s12, s12, 55552
    v_add_u32 v244, s12, v102
    v_add_u32 v103, 10240, v244
    v_cmp_gt_u32 vcc, 16, v0
    s_nop 1
    v_cndmask_b32 v245, v244, v103, vcc
    v_cmp_gt_u32 vcc, 32, v0
    s_nop 1
    v_cndmask_b32 v246, v244, v103, vcc
    v_cmp_gt_u32 vcc, 48, v0
    s_nop 1
    v_cndmask_b32 v247, v244, v103, vcc
    s_mov_b32 s56, s32
    s_mov_b32 s57, s33
    s_mov_b32 s58, 2621440
    s_mov_b32 s59, 0x20000
    s_mul_i32 s12, s60, 10
    s_mul_i32 s11, s61, 5
    s_add_u32 s12, s12, s11
    s_lshl_b32 s63, s12, 7
    s_add_u32 s63, s63, 2818048
    s_and_b32 s11, s5, 3
    s_mul_i32 s11, s11, 9920
    s_add_u32 s11, s11, 160
    v_mul_u32_u24 v101, 240, v101
    v_add3_u32 v232, v101, v254, s11
    s_lshl_b32 s22, s12, 11
    s_add_u32 s22, s22, 3145728
    s_add_u32 s23, s22, 4096
    s_add_u32 s24, s22, 8192
    s_cmp_ge_u32 s60, 36
    s_cselect_b32 s11, 1, 0
    s_cmpk_ge_u32 s60, 66
    s_addc_u32 s11, s11, 0
    s_cmpk_ge_u32 s60, 102
    s_addc_u32 s11, s11, 0
    s_lshl_b32 s11, s11, 1
    s_add_u32 s11, s11, s61
    s_cmp_eq_u32 s11, s3
    s_cselect_b32 s100, 1, 0
    v_lshrrev_b32 v3, 4, v28
    v_subrev_u32 v4, 96, v28
    v_cmp_gt_u32 vcc, 96, v28
    s_nop 1
    v_cndmask_b32 v3, v4, v3, vcc
    s_mul_i32 s13, s6, 6
    v_add_u32 v4, s13, v3
    v_mul_u32_u24 v5, 10, v4
    v_add_u32 v5, s8, v5
    v_and_b32 v36, 15, v28
    v_lshl_add_u32 v36, v5, 4, v36
    v_add_u32 v36, 24576, v36
    v_add_u32 v5, 22016, v5
    v_cndmask_b32 v36, v5, v36, vcc
    v_lshrrev_b32 v4, 4, v4
    v_cmp_eq_u32 vcc, s3, v4
    v_cmp_gt_u32 s[12:13], 6, v3
    s_and_b64 vcc, vcc, s[12:13]
    v_mov_b32 v37, 0xfe0000
    v_cndmask_b32 v36, v37, v36, vcc
    s_mul_i32 s11, s6, 10
    s_add_u32 s11, s11, s8
    s_mul_i32 s11, s11, 48
    s_add_u32 s11, s11, 384
    v_add_u32 v5, s11, v28
    s_cmp_eq_u32 s7, 0
    s_cselect_b32 s12, 24, 0
    s_add_u32 s12, s12, 128
    s_cmp_eq_u32 s7, 4
    s_cselect_b32 s13, 24, 48
    s_add_u32 s13, s13, 128
    v_cmp_le_u32 vcc, s12, v28
    s_nop 1
    v_cndmask_b32 v36, v36, v5, vcc
    v_cmp_le_u32 vcc, s13, v28
    s_nop 1
    v_cndmask_b32 v36, v36, v37, vcc
    v_lshlrev_b32 v36, 7, v36
    s_lshl_b32 s11, s68, 7
    s_mul_i32 s39, s68, 245760
    s_add_u32 m0, s69, 77824
    s_mov_b64 exec, s[72:73]
    buffer_load_dwordx4 v10, s[40:43], s11 offen lds
    s_mov_b64 exec, -1
    s_add_u32 m0, s69, 81920
    s_nop 0
    buffer_load_dwordx4 v11, s[40:43], s11 offen lds
    s_add_u32 m0, s69, 86016
    s_nop 0
    buffer_load_dwordx4 v12, s[40:43], s11 offen lds
    s_cmp_ge_u32 s14, 2
    s_cbranch_scc1 L_xs_2
    s_add_u32 m0, s69, 90112
    s_nop 0
    buffer_load_dwordx4 v13, s[40:43], s11 offen lds
L_xs_2:
    s_add_u32 s68, s68, 1
    s_cmp_eq_u32 s68, 10
    s_cselect_b32 s68, 0, s68
    s_add_u32 m0, s69, 92160
    s_add_u32 s13, s39, 0
    buffer_load_dwordx4 v14, s[44:47], s13 offen lds
    s_add_u32 m0, s69, 100352
    s_add_u32 s13, s39, 1280
    buffer_load_dwordx4 v14, s[44:47], s13 offen lds
    s_add_u32 m0, s69, 108544
    s_add_u32 s13, s39, 2560
    buffer_load_dwordx4 v14, s[44:47], s13 offen lds
    s_add_u32 m0, s69, 96256
    s_add_u32 s13, s39, 122880
    buffer_load_dwordx4 v14, s[44:47], s13 offen lds
    s_add_u32 m0, s69, 104448
    s_add_u32 s13, s39, 124160
    buffer_load_dwordx4 v14, s[44:47], s13 offen lds
    s_add_u32 m0, s69, 112640
    s_add_u32 s13, s39, 125440
    buffer_load_dwordx4 v14, s[44:47], s13 offen lds
    s_waitcnt lgkmcnt(0)
    s_add_u32 s10, s10, 1
    s_waitcnt vmcnt(9)
    s_barrier
    s_lshl_b32 s11, s68, 7
    s_mul_i32 s39, s68, 245760
    s_add_u32 m0, s69, 116736
    s_mov_b64 exec, s[72:73]
    buffer_load_dwordx4 v10, s[40:43], s11 offen lds
    s_mov_b64 exec, -1
    s_add_u32 m0, s69, 120832
    s_nop 0
    buffer_load_dwordx4 v11, s[40:43], s11 offen lds
    s_add_u32 m0, s69, 124928
    s_nop 0
    buffer_load_dwordx4 v12, s[40:43], s11 offen lds
    s_cmp_ge_u32 s14, 2
    s_cbranch_scc1 L_xs_3
    s_add_u32 m0, s69, 129024
    s_nop 0
    buffer_load_dwordx4 v13, s[40:43], s11 offen lds
L_xs_3:
    s_add_u32 s68, s68, 1
    s_cmp_eq_u32 s68, 10
    s_cselect_b32 s68, 0, s68
    s_add_u32 m0, s69, 131072
    s_add_u32 s13, s39, 0
    buffer_load_dwordx4 v14, s[44:47], s13 offen lds
    s_add_u32 m0, s69, 139264
    s_add_u32 s13, s39, 1280
    buffer_load_dwordx4 v14, s[44:47], s13 offen lds
    s_add_u32 m0, s69, 147456
    s_add_u32 s13, s39, 2560
    buffer_load_dwordx4 v14, s[44:47], s13 offen lds
    s_add_u32 m0, s69, 135168
    s_add_u32 s13, s39, 122880
    buffer_load_dwordx4 v14, s[44:47], s13 offen lds
    s_add_u32 m0, s69, 143360
    s_add_u32 s13, s39, 124160
    buffer_load_dwordx4 v14, s[44:47], s13 offen lds
    s_add_u32 m0, s69, 151552
    s_add_u32 s13, s39, 125440
    buffer_load_dwordx4 v14, s[44:47], s13 offen lds
    s_waitcnt vmcnt(9)
    s_barrier
    s_lshl_b32 s11, s68, 7
    s_mul_i32 s39, s68, 245760
    s_add_u32 m0, s69, 0
    s_mov_b64 exec, s[72:73]
    buffer_load_dwordx4 v10, s[40:43], s11 offen lds
    s_mov_b64 exec, -1
    s_add_u32 m0, s69, 4096
    s_nop 0
    buffer_load_dwordx4 v11, s[40:43], s11 offen lds
    s_add_u32 m0, s69, 8192
    s_nop 0
    buffer_load_dwordx4 v12, s[40:43], s11 offen lds
    s_cmp_ge_u32 s14, 2
    s_cbranch_scc1 L_xs_4
    s_add_u32 m0, s69, 12288
    s_nop 0
    buffer_load_dwordx4 v13, s[40:43], s11 offen lds
L_xs_4:
    s_add_u32 s68, s68, 1
    s_cmp_eq_u32 s68, 10
    s_cselect_b32 s68, 0, s68
    s_add_u32 m0, s69, 14336
    s_add_u32 s13, s39, 0
    buffer_load_dwordx4 v14, s[44:47], s13 offen lds
    s_add_u32 m0, s69, 22528
    s_add_u32 s13, s39, 1280
    buffer_load_dwordx4 v14, s[44:47], s13 offen lds
    s_add_u32 m0, s69, 30720
    s_add_u32 s13, s39, 2560
    buffer_load_dwordx4 v14, s[44:47], s13 offen lds
    s_add_u32 m0, s69, 18432
    s_add_u32 s13, s39, 122880
    buffer_load_dwordx4 v14, s[44:47], s13 offen lds
    s_add_u32 m0, s69, 26624
    s_add_u32 s13, s39, 124160
    buffer_load_dwordx4 v14, s[44:47], s13 offen lds
    s_add_u32 m0, s69, 34816
    s_add_u32 s13, s39, 125440
    buffer_load_dwordx4 v14, s[44:47], s13 offen lds
    s_waitcnt vmcnt(9)
    s_barrier
    s_lshl_b32 s11, s68, 7
    s_mul_i32 s39, s68, 245760
    s_add_u32 m0, s69, 38912
    s_mov_b64 exec, s[72:73]
    buffer_load_dwordx4 v10, s[40:43], s11 offen lds
    s_mov_b64 exec, -1
    s_add_u32 m0, s69, 43008
    s_nop 0
    buffer_load_dwordx4 v11, s[40:43], s11 offen lds
    s_add_u32 m0, s69, 47104
    s_nop 0
    buffer_load_dwordx4 v12, s[40:43], s11 offen lds
    s_cmp_ge_u32 s14, 2
    s_cbranch_scc1 L_xs_5
    s_add_u32 m0, s69, 51200
    s_nop 0
    buffer_load_dwordx4 v13, s[40:43], s11 offen lds
L_xs_5:
    s_add_u32 s68, s68, 1
    s_cmp_eq_u32 s68, 10
    s_cselect_b32 s68, 0, s68
    s_add_u32 m0, s69, 53248
    s_add_u32 s13, s39, 0
    buffer_load_dwordx4 v14, s[44:47], s13 offen lds
    s_add_u32 m0, s69, 61440
    s_add_u32 s13, s39, 1280
    buffer_load_dwordx4 v14, s[44:47], s13 offen lds
    s_add_u32 m0, s69, 69632
    s_add_u32 s13, s39, 2560
    buffer_load_dwordx4 v14, s[44:47], s13 offen lds
    s_add_u32 m0, s69, 57344
    s_add_u32 s13, s39, 122880
    buffer_load_dwordx4 v14, s[44:47], s13 offen lds
    s_add_u32 m0, s69, 65536
    s_add_u32 s13, s39, 124160
    buffer_load_dwordx4 v14, s[44:47], s13 offen lds
    s_add_u32 m0, s69, 73728
    s_add_u32 s13, s39, 125440
    buffer_load_dwordx4 v14, s[44:47], s13 offen lds
    s_waitcnt vmcnt(9)
    s_barrier
    s_lshl_b32 s11, s68, 7
    s_mul_i32 s39, s68, 245760
    s_add_u32 m0, s69, 77824
    s_mov_b64 exec, s[72:73]
    buffer_load_dwordx4 v10, s[40:43], s11 offen lds
    s_mov_b64 exec, -1
    s_add_u32 m0, s69, 81920
    s_nop 0
    buffer_load_dwordx4 v11, s[40:43], s11 offen lds
    s_add_u32 m0, s69, 86016
    s_nop 0
    buffer_load_dwordx4 v12, s[40:43], s11 offen lds
    s_cmp_ge_u32 s14, 2
    s_cbranch_scc1 L_xs_6
    s_add_u32 m0, s69, 90112
    s_nop 0
    buffer_load_dwordx4 v13, s[40:43], s11 offen lds
L_xs_6:
    s_add_u32 s68, s68, 1
    s_cmp_eq_u32 s68, 10
    s_cselect_b32 s68, 0, s68
    s_add_u32 m0, s69, 92160
    s_add_u32 s13, s39, 0
    buffer_load_dwordx4 v14, s[44:47], s13 offen lds
    s_add_u32 m0, s69, 100352
    s_add_u32 s13, s39, 1280
    buffer_load_dwordx4 v14, s[44:47], s13 offen lds
    s_add_u32 m0, s69, 108544
    s_add_u32 s13, s39, 2560
    buffer_load_dwordx4 v14, s[44:47], s13 offen lds
    s_add_u32 m0, s69, 96256
    s_add_u32 s13, s39, 122880
    buffer_load_dwordx4 v14, s[44:47], s13 offen lds
    s_add_u32 m0, s69, 104448
    s_add_u32 s13, s39, 124160
    buffer_load_dwordx4 v14, s[44:47], s13 offen lds
    s_add_u32 m0, s69, 112640
    s_add_u32 s13, s39, 125440
    buffer_load_dwordx4 v14, s[44:47], s13 offen lds
    s_waitcnt vmcnt(9)
    s_barrier
    s_lshl_b32 s11, s68, 7
    s_mul_i32 s39, s68, 245760
    s_add_u32 m0, s69, 116736
    s_mov_b64 exec, s[72:73]
    buffer_load_dwordx4 v10, s[40:43], s11 offen lds
    s_mov_b64 exec, -1
    s_add_u32 m0, s69, 120832
    s_nop 0
    buffer_load_dwordx4 v11, s[40:43], s11 offen lds
    s_add_u32 m0, s69, 124928
    s_nop 0
    buffer_load_dwordx4 v12, s[40:43], s11 offen lds
    s_cmp_ge_u32 s14, 2
    s_cbranch_scc1 L_xs_7
    s_add_u32 m0, s69, 129024
    s_nop 0
    buffer_load_dwordx4 v13, s[40:43], s11 offen lds
L_xs_7:
    s_add_u32 s68, s68, 1
    s_cmp_eq_u32 s68, 10
    s_cselect_b32 s68, 0, s68
    s_add_u32 m0, s69, 131072
    s_add_u32 s13, s39, 0
    buffer_load_dwordx4 v14, s[44:47], s13 offen lds
    s_add_u32 m0, s69, 139264
    s_add_u32 s13, s39, 1280
    buffer_load_dwordx4 v14, s[44:47], s13 offen lds
    s_add_u32 m0, s69, 147456
    s_add_u32 s13, s39, 2560
    buffer_load_dwordx4 v14, s[44:47], s13 offen lds
    s_add_u32 m0, s69, 135168
    s_add_u32 s13, s39, 122880
    buffer_load_dwordx4 v14, s[44:47], s13 offen lds
    s_add_u32 m0, s69, 143360
    s_add_u32 s13, s39, 124160
    buffer_load_dwordx4 v14, s[44:47], s13 offen lds
    s_add_u32 m0, s69, 151552
    s_add_u32 s13, s39, 125440
    buffer_load_dwordx4 v14, s[44:47], s13 offen lds
    s_lshl_b32 s11, s68, 7
    s_mul_i32 s39, s68, 245760
    s_add_u32 m0, s69, 0
    s_mov_b64 exec, s[72:73]
    buffer_load_dwordx4 v10, s[40:43], s11 offen lds
    s_mov_b64 exec, -1
    s_add_u32 m0, s69, 4096
    s_nop 0
    buffer_load_dwordx4 v11, s[40:43], s11 offen lds
    s_add_u32 m0, s69, 8192
    s_nop 0
    buffer_load_dwordx4 v12, s[40:43], s11 offen lds
    s_cmp_ge_u32 s14, 2
    s_cbranch_scc1 L_xs_8
    s_add_u32 m0, s69, 12288
    s_nop 0
    buffer_load_dwordx4 v13, s[40:43], s11 offen lds
L_xs_8:
    s_add_u32 s68, s68, 1
    s_cmp_eq_u32 s68, 10
    s_cselect_b32 s68, 0, s68
    s_waitcnt vmcnt(12)
    s_barrier
    s_add_u32 m0, s69, 14336
    s_add_u32 s13, s39, 0
    buffer_load_dwordx4 v14, s[44:47], s13 offen lds
    s_add_u32 m0, s69, 22528
    s_add_u32 s13, s39, 1280
    buffer_load_dwordx4 v14, s[44:47], s13 offen lds
    s_add_u32 m0, s69, 30720
    s_add_u32 s13, s39, 2560
    buffer_load_dwordx4 v14, s[44:47], s13 offen lds
    s_add_u32 m0, s69, 18432
    s_add_u32 s13, s39, 122880
    buffer_load_dwordx4 v14, s[44:47], s13 offen lds
    s_add_u32 m0, s69, 26624
    s_add_u32 s13, s39, 124160
    buffer_load_dwordx4 v14, s[44:47], s13 offen lds
    s_add_u32 m0, s69, 34816
    s_add_u32 s13, s39, 125440
    buffer_load_dwordx4 v14, s[44:47], s13 offen lds
    s_lshl_b32 s11, s68, 7
    s_mul_i32 s39, s68, 245760
    s_add_u32 m0, s69, 38912
    s_mov_b64 exec, s[72:73]
    buffer_load_dwordx4 v10, s[40:43], s11 offen lds
    s_mov_b64 exec, -1
    s_add_u32 m0, s69, 43008
    s_nop 0
    buffer_load_dwordx4 v11, s[40:43], s11 offen lds
    s_add_u32 m0, s69, 47104
    s_nop 0
    buffer_load_dwordx4 v12, s[40:43], s11 offen lds
    s_cmp_ge_u32 s14, 2
    s_cbranch_scc1 L_xs_9
    s_add_u32 m0, s69, 51200
    s_nop 0
    buffer_load_dwordx4 v13, s[40:43], s11 offen lds
L_xs_9:
    s_add_u32 s68, s68, 1
    s_cmp_eq_u32 s68, 10
    s_cselect_b32 s68, 0, s68
    s_add_u32 m0, s69, 53248
    s_add_u32 s13, s39, 0
    buffer_load_dwordx4 v14, s[44:47], s13 offen lds
    s_add_u32 m0, s69, 61440
    s_add_u32 s13, s39, 1280
    buffer_load_dwordx4 v14, s[44:47], s13 offen lds
    s_add_u32 m0, s69, 69632
    s_add_u32 s13, s39, 2560
    buffer_load_dwordx4 v14, s[44:47], s13 offen lds
    v_and_b32 v34, 31, v0
    v_lshlrev_b32 v34, 2, v34
    s_lshl_b32 s11, s3, 7
    s_add_u32 s11, s11, 3014656
    buffer_load_dword v35, v34, s[52:55], s11 offen sc1
    buffer_load_dwordx2 v[30:31], v27, s[52:55], 0 offen sc1
    s_waitcnt vmcnt(17)
    s_barrier
    s_add_u32 m0, s69, 57344
    s_add_u32 s13, s39, 122880
    buffer_load_dwordx4 v14, s[44:47], s13 offen lds
    s_add_u32 m0, s69, 65536
    s_add_u32 s13, s39, 124160
    buffer_load_dwordx4 v14, s[44:47], s13 offen lds
    s_add_u32 m0, s69, 73728
    s_add_u32 s13, s39, 125440
    buffer_load_dwordx4 v14, s[44:47], s13 offen lds
    s_lshl_b32 s11, s68, 7
    s_mul_i32 s39, s68, 245760
    s_add_u32 m0, s69, 77824
    s_mov_b64 exec, s[72:73]
    buffer_load_dwordx4 v10, s[40:43], s11 offen lds
    s_mov_b64 exec, -1
    s_add_u32 m0, s69, 81920
    s_nop 0
    buffer_load_dwordx4 v11, s[40:43], s11 offen lds
    s_add_u32 m0, s69, 86016
    s_nop 0
    buffer_load_dwordx4 v12, s[40:43], s11 offen lds
    s_cmp_ge_u32 s14, 2
    s_cbranch_scc1 L_xs_10
    s_add_u32 m0, s69, 90112
    s_nop 0
    buffer_load_dwordx4 v13, s[40:43], s11 offen lds
L_xs_10:
    s_add_u32 s68, s68, 1
    s_cmp_eq_u32 s68, 10
    s_cselect_b32 s68, 0, s68
    s_add_u32 m0, s69, 92160
    s_add_u32 s13, s39, 0
    buffer_load_dwordx4 v14, s[44:47], s13 offen lds
    s_add_u32 m0, s69, 100352
    s_add_u32 s13, s39, 1280
    buffer_load_dwordx4 v14, s[44:47], s13 offen lds
    s_add_u32 m0, s69, 108544
    s_add_u32 s13, s39, 2560
    buffer_load_dwordx4 v14, s[44:47], s13 offen lds
    s_add_u32 m0, s69, 96256
    s_add_u32 s13, s39, 122880
    buffer_load_dwordx4 v14, s[44:47], s13 offen lds
    s_add_u32 m0, s69, 104448
    s_add_u32 s13, s39, 124160
    buffer_load_dwordx4 v14, s[44:47], s13 offen lds
    s_add_u32 m0, s69, 112640
    s_add_u32 s13, s39, 125440
    buffer_load_dwordx4 v14, s[44:47], s13 offen lds
    buffer_load_dword v37, v36, s[52:55], 0 offen
    s_waitcnt vmcnt(21)
    s_barrier
    s_and_b32 s71, s4, 2
    s_lshl_b32 s71, s71, 1
    s_add_u32 s71, s71, s14
    s_add_u32 s71, s71, 12
    s_add_u32 s12, s71, s70
    s_cmp_ge_u32 s12, 20
    s_cselect_b32 s13, 20, 0
    s_sub_u32 s12, s12, s13
    s_mul_i32 s12, s12, 40960
    s_mul_i32 s13, s71, 5120
    s_add_u32 s13, s13, 55552
    s_add_u32 m0, s13, 0
    s_nop 0
    buffer_load_dwordx4 v20, s[48:51], s12 offen lds
    s_add_u32 m0, s13, 1024
    s_nop 0
    buffer_load_dwordx4 v21, s[48:51], s12 offen lds
    s_add_u32 m0, s13, 2048
    s_nop 0
    buffer_load_dwordx4 v22, s[48:51], s12 offen lds
    s_add_u32 m0, s13, 3072
    s_nop 0
    buffer_load_dwordx4 v23, s[48:51], s12 offen lds
    s_add_u32 m0, s13, 4096
    s_nop 0
    buffer_load_dwordx4 v24, s[48:51], s12 offen lds
    s_waitcnt vmcnt(15)
    s_barrier
    s_mov_b32 s15, 200000
    s_movk_i32 s75, 2048
    v_cmp_gt_u32 s[76:77], s75, v26
L_tchk:
    v_cmp_ne_u32 vcc, s10, v31
    s_and_b64 vcc, vcc, s[76:77]
    s_cmp_eq_u64 vcc, 0
    s_cbranch_scc1 L_tok
    s_sub_u32 s15, s15, 1
    s_cmp_eq_u32 s15, 0
    s_cbranch_scc1 L_tok
    s_sleep 4
    buffer_load_dwordx2 v[30:31], v27, s[52:55], 0 offen sc1
    s_waitcnt vmcnt(0)
    s_branch L_tchk
L_tok:
    v_mov_b32 v32, 0x3f800000
    v_cndmask_b32 v30, v32, v30, s[76:77]
    v_and_b32 v32, 0xffff0000, v30
    v_rcp_f32 v32, v32
    v_lshlrev_b32 v30, 16, v30
    v_mul_f32 v33, -v30, v32
    v_lshlrev_b32 v29, 3, v28
    v_add_u32 v29, 157952, v29
    v_cmp_le_u32 vcc, 112, v28
    s_nop 1
    v_cndmask_b32 v32, v32, 0, vcc
    v_cndmask_b32 v33, v33, 0, vcc
    s_getreg_b32 s11, hwreg(HW_REG_XCC_ID, 0, 4)
    s_lshl_b32 s11, s11, 28
    s_xor_b32 s11, s11, s10
    v_cmp_ne_u32 vcc, s11, v35
    s_cmp_eq_u64 vcc, 0
    s_cselect_b32 s9, 1, 0
    v_mov_b32 v30, s9
    v_cmp_eq_u32 vcc, 114, v28
    s_nop 1
    v_cndmask_b32 v32, v32, v30, vcc
    v_cmp_ge_u32 vcc, 114, v28
    s_and_b64 exec, exec, vcc
    ds_write_b64 v29, v[32:33]
    s_mov_b64 exec, -1
    s_waitcnt lgkmcnt(0)
    s_waitcnt vmcnt(6)
    s_barrier
    v_lshrrev_b32 v3, 1, v28
    v_and_b32 v4, 1, v28
    v_mul_u32_u24 v3, 496, v3
    v_mul_u32_u24 v4, 160, v4
    v_add_u32 v3, v3, v4
    v_mov_b32 v4, 0
    v_mov_b32 v5, 0
    v_cmp_gt_u32 vcc, 224, v28
    s_and_b64 exec, exec, vcc
    s_cmp_gt_u32 s7, 0
    s_cselect_b32 s11, 0, 128
    v_add_u32 v6, s11, v3
    ds_write_b64 v6, v[4:5]
    s_cmp_gt_u32 s7, 1
    s_cselect_b32 s11, 8, 136
    v_add_u32 v6, s11, v3
    ds_write_b64 v6, v[4:5]
    s_cmp_gt_u32 s7, 2
    s_cselect_b32 s11, 16, 144
    v_add_u32 v6, s11, v3
    ds_write_b64 v6, v[4:5]
    s_cmp_gt_u32 s7, 3
    s_cselect_b32 s11, 24, 152
    v_add_u32 v6, s11, v3
    ds_write_b64 v6, v[4:5]
    s_mov_b64 exec, -1
    v_mov_b32 v8, 158848
    v_mov_b32 v3, 1
    s_waitcnt lgkmcnt(0)
    s_mov_b64 exec, 1
    ds_add_u32 v8, v3 offset:12
    s_mov_b64 exec, -1
    s_and_b32 s71, s4, 2
    s_lshl_b32 s71, s71, 1
    s_sub_u32 s71, s14, s71
    s_add_u32 s71, s71, 16
    s_add_u32 s12, s71, s70
    s_cmp_ge_u32 s12, 20
    s_cselect_b32 s13, 20, 0
    s_sub_u32 s12, s12, s13
    s_mul_i32 s12, s12, 40960
    s_mul_i32 s13, s71, 5120
    s_add_u32 s13, s13, 55552
    s_add_u32 m0, s13, 0
    s_nop 0
    buffer_load_dwordx4 v20, s[48:51], s12 offen lds
    s_add_u32 m0, s13, 1024
    s_nop 0
    buffer_load_dwordx4 v21, s[48:51], s12 offen lds
    s_add_u32 m0, s13, 2048
    s_nop 0
    buffer_load_dwordx4 v22, s[48:51], s12 offen lds
    s_add_u32 m0, s13, 3072
    s_nop 0
    buffer_load_dwordx4 v23, s[48:51], s12 offen lds
    s_add_u32 m0, s13, 4096
    s_nop 0
    buffer_load_dwordx4 v24, s[48:51], s12 offen lds
    s_cmp_ge_u32 s14, 2
    s_cbranch_scc1 L_w67
    buffer_load_dwordx2 v[160:161], v235, s[52:55], 0 offen sc1
    buffer_load_dwordx4 v[162:165], v233, s[40:43], 0 offen
    buffer_load_dwordx4 v[166:169], v233, s[40:43], 0 offen offset:64
    buffer_load_dwordx2 v[170:171], v234, s[40:43], 0 offen offset:128
    s_mov_b32 s64, 0xaaaaaaaa
    s_mov_b32 s65, 0xaaaaaaaa
    s_mov_b32 s66, 0xfff0ffff
    s_mov_b32 s67, 0xf000ff00
    s_mov_b32 s68, 0xffc0fffc
    s_mov_b32 s69, 0xc000fc00
    s_getreg_b32 s74, hwreg(HW_REG_XCC_ID, 0, 4)
    s_lshl_b32 s74, s74, 12
    s_xor_b32 s74, s74, s10
    s_and_b32 s74, s74, 0xffff
    s_and_b32 s75, s74, 0xff
    s_lshr_b32 s39, s74, 8
    s_mul_i32 s12, s6, 10
    s_add_u32 s12, s12, s8
    s_mul_i32 s12, s12, 12
    s_add_u32 s12, s12, s5
    s_lshl_b32 s12, s12, 9
    s_add_u32 s12, s12, 65536
    s_mov_b32 s13, 0x7f000000
    s_sub_u32 s14, s12, 3072
    s_cmp_ge_u32 s7, 1
    s_cselect_b32 s70, s12, s13
    s_cselect_b32 s72, s14, s13
    s_cselect_b32 s76, s74, 0
    s_add_u32 s14, s12, 3072
    s_add_u32 s12, s12, 6144
    s_cmp_le_u32 s7, 3
    s_cselect_b32 s71, s14, s13
    s_cselect_b32 s73, s12, s13
    s_cselect_b32 s77, s74, 0
    s_lshl_b32 s11, s7, 3
    s_lshl_b64 s[28:29], -1, s11
    s_lshl_b64 s[28:29], s[28:29], s11
    s_mul_i32 s12, s6, 6
    s_add_u32 s12, s12, s5
    s_lshr_b32 s11, s12, 4
    s_cmp_eq_u32 s11, s3
    s_cselect_b32 s31, 1, 0
    s_mul_i32 s14, s12, 10
    s_add_u32 s14, s14, s8
    s_lshl_b32 s25, s14, 11
    s_add_u32 s25, s25, 3145728
    s_lshl_b32 s26, s14, 7
    s_add_u32 s26, s26, 2818048
    s_cmpk_ge_u32 s12, 128
    s_cselect_b32 s25, s13, s25
    s_cselect_b32 s26, s13, s26
    s_mov_b32 s38, 3
    s_branch L_img2
L_w67:
    s_mov_b32 s38, 2
    s_cmp_eq_u32 s14, 3
    s_cbranch_scc1 L_w7
    s_mov_b32 s71, 0
L_w6:
    s_add_u32 s12, s71, s70
    s_cmp_ge_u32 s12, 20
    s_cselect_b32 s13, 20, 0
    s_sub_u32 s12, s12, s13
    s_mul_i32 s12, s12, 40960
    s_mul_i32 s13, s71, 5120
    s_add_u32 s13, s13, 55552
    s_add_u32 m0, s13, 0
    s_nop 0
    buffer_load_dwordx4 v20, s[48:51], s12 offen lds
    s_add_u32 m0, s13, 1024
    s_nop 0
    buffer_load_dwordx4 v21, s[48:51], s12 offen lds
    s_add_u32 m0, s13, 2048
    s_nop 0
    buffer_load_dwordx4 v22, s[48:51], s12 offen lds
    s_add_u32 m0, s13, 3072
    s_nop 0
    buffer_load_dwordx4 v23, s[48:51], s12 offen lds
    s_add_u32 m0, s13, 4096
    s_nop 0
    buffer_load_dwordx4 v24, s[48:51], s12 offen lds
    s_add_u32 s71, s71, 1
    s_cmp_lt_u32 s71, 4
    s_cbranch_scc1 L_w6
    s_branch L_p2wo
L_w7:
    s_mov_b32 s15, 800000
L_w7a:
    ds_read_b32 v3, v8 offset:8
    s_waitcnt lgkmcnt(0)
    v_readfirstlane_b32 s11, v3
    s_cmp_ge_u32 s11, 4
    s_cbranch_scc1 L_w7b
    s_sleep 1
    s_sub_u32 s15, s15, 1
    s_cmp_lg_u32 s15, 0
    s_cbranch_scc1 L_w7a
L_w7b:
    s_mov_b32 s71, 4
L_w7c:
    s_add_u32 s12, s71, s70
    s_cmp_ge_u32 s12, 20
    s_cselect_b32 s13, 20, 0
    s_sub_u32 s12, s12, s13
    s_mul_i32 s12, s12, 40960
    s_mul_i32 s13, s71, 5120
    s_add_u32 s13, s13, 55552
    s_add_u32 m0, s13, 0
    s_nop 0
    buffer_load_dwordx4 v20, s[48:51], s12 offen lds
    s_add_u32 m0, s13, 1024
    s_nop 0
    buffer_load_dwordx4 v21, s[48:51], s12 offen lds
    s_add_u32 m0, s13, 2048
    s_nop 0
    buffer_load_dwordx4 v22, s[48:51], s12 offen lds
    s_add_u32 m0, s13, 3072
    s_nop 0
    buffer_load_dwordx4 v23, s[48:51], s12 offen lds
    s_add_u32 m0, s13, 4096
    s_nop 0
    buffer_load_dwordx4 v24, s[48:51], s12 offen lds
    s_add_u32 s71, s71, 1
    s_cmp_lt_u32 s71, 12
    s_cbranch_scc1 L_w7c
    s_branch L_p2wo
L_expert2:
    s_load_dword s10, s[36:37], 0
    s_mov_b32 s40, s16
    s_mov_b32 s41, s17
    s_mov_b32 s42, 2621440
    s_mov_b32 s43, 0x20000
    s_mov_b32 s52, s36
    s_mov_b32 s53, s37
    s_mov_b32 s54, 11534336
    s_mov_b32 s55, 0x20000
    s_lshl_b32 s60, s3, 2
    s_and_b32 s11, s4, 3
    s_add_u32 s60, s60, s11
    s_lshl_b32 s60, s60, 2
    s_and_b32 s12, s5, 3
    s_add_u32 s60, s60, s12
    s_lshr_b32 s61, s5, 2
    s_xor_b32 s61, s61, s3
    s_and_b32 s61, s61, 1
    s_lshr_b32 s62, s4, 2
    s_mul_i32 s62, s62, 80
    s_mov_b32 s38, 0
    v_and_b32 v100, 15, v0
    v_lshrrev_b32 v101, 4, v0
    s_lshl_b32 s12, s60, 4
    v_add_u32 v102, s12, v100
    v_lshlrev_b32 v235, 3, v102
    v_add_u32 v235, 4096, v235
    v_mul_u32_u24 v102, 1280, v102
    v_lshl_add_u32 v102, v101, 3, v102
    s_lshl_b32 s12, s62, 1
    v_add_u32 v234, s12, v102
    v_lshlrev_b32 v254, 4, v0
    v_and_b32 v102, 1, v101
    v_mul_u32_u24 v102, 24, v102
    v_add_u32 v233, v234, v102
    v_lshrrev_b32 v102, 2, v0
    v_and_b32 v103, 3, v0
    v_mul_u32_u24 v102, 160, v102
    v_lshl_add_u32 v102, v103, 3, v102
    s_xor_b32 s12, s61, s11
    s_and_b32 s12, s12, 1
    s_mul_i32 s12, s12, 51200
    s_add_u32 s12, s12, 55552
    v_add_u32 v244, s12, v102
    v_add_u32 v103, 10240, v244
    v_cmp_gt_u32 vcc, 16, v0
    s_nop 1
    v_cndmask_b32 v245, v244, v103, vcc
    v_cmp_gt_u32 vcc, 32, v0
    s_nop 1
    v_cndmask_b32 v246, v244, v103, vcc
    v_cmp_gt_u32 vcc, 48, v0
    s_nop 1
    v_cndmask_b32 v247, v244, v103, vcc
    s_mov_b32 s56, s32
    s_mov_b32 s57, s33
    s_mov_b32 s58, 2621440
    s_mov_b32 s59, 0x20000
    s_mul_i32 s12, s60, 10
    s_mul_i32 s11, s61, 5
    s_add_u32 s12, s12, s11
    s_lshl_b32 s63, s12, 7
    s_add_u32 s63, s63, 2818048
    s_and_b32 s11, s5, 3
    s_mul_i32 s11, s11, 9920
    s_add_u32 s11, s11, 160
    v_mul_u32_u24 v101, 240, v101
    v_add3_u32 v232, v101, v254, s11
    s_lshl_b32 s22, s12, 11
    s_add_u32 s22, s22, 3145728
    s_add_u32 s23, s22, 4096
    s_add_u32 s24, s22, 8192
    s_cmp_ge_u32 s60, 36
    s_cselect_b32 s11, 1, 0
    s_cmpk_ge_u32 s60, 66
    s_addc_u32 s11, s11, 0
    s_cmpk_ge_u32 s60, 102
    s_addc_u32 s11, s11, 0
    s_lshl_b32 s11, s11, 1
    s_add_u32 s11, s11, s61
    s_cmp_eq_u32 s11, s3
    s_cselect_b32 s100, 1, 0
    s_mov_b32 s48, s20
    s_mov_b32 s49, s21
    s_mov_b32 s50, 819200
    s_mov_b32 s51, 0x20000
    s_lshr_b32 s11, s4, 2
    s_mul_i32 s11, s11, 160
    s_and_b32 s70, s4, 1
    s_mul_i32 s70, s70, 10
    v_add_u32 v2, 0, v0
    v_mul_u32_u24 v3, 6554, v2
    v_lshrrev_b32 v3, 16, v3
    v_mul_u32_u24 v4, 10, v3
    v_sub_u32 v4, v2, v4
    v_mul_u32_u24 v3, 1280, v3
    v_lshl_add_u32 v3, v4, 4, v3
    v_add_u32 v11, s11, v3
    v_add_u32 v2, 64, v0
    v_mul_u32_u24 v3, 6554, v2
    v_lshrrev_b32 v3, 16, v3
    v_mul_u32_u24 v4, 10, v3
    v_sub_u32 v4, v2, v4
    v_mul_u32_u24 v3, 1280, v3
    v_lshl_add_u32 v3, v4, 4, v3
    v_add_u32 v12, s11, v3
    v_add_u32 v2, 128, v0
    v_mul_u32_u24 v3, 6554, v2
    v_lshrrev_b32 v3, 16, v3
    v_mul_u32_u24 v4, 10, v3
    v_sub_u32 v4, v2, v4
    v_mul_u32_u24 v3, 1280, v3
    v_lshl_add_u32 v3, v4, 4, v3
    v_add_u32 v13, s11, v3
    v_add_u32 v2, 192, v0
    v_mul_u32_u24 v3, 6554, v2
    v_lshrrev_b32 v3, 16, v3
    v_mul_u32_u24 v4, 10, v3
    v_sub_u32 v4, v2, v4
    v_mul_u32_u24 v3, 1280, v3
    v_lshl_add_u32 v3, v4, 4, v3
    v_add_u32 v14, s11, v3
    v_add_u32 v2, 256, v0
    v_mul_u32_u24 v3, 6554, v2
    v_lshrrev_b32 v3, 16, v3
    v_mul_u32_u24 v4, 10, v3
    v_sub_u32 v4, v2, v4
    v_mul_u32_u24 v3, 1280, v3
    v_lshl_add_u32 v3, v4, 4, v3
    v_add_u32 v15, s11, v3
    v_and_b32 v1, 15, v0
    v_lshrrev_b32 v2, 4, v0
    v_lshrrev_b32 v3, 2, v1
    v_and_b32 v4, 3, v1
    v_lshrrev_b32 v5, 1, v3
    v_and_b32 v6, 1, v2
    v_lshl_or_b32 v5, v6, 1, v5
    s_lshl_b32 s11, s14, 1
    v_xor_b32 v5, s11, v5
    v_lshl_add_u32 v7, v2, 3, v3
    v_lshlrev_b32 v8, 7, v7
    v_lshl_add_u32 v8, v5, 5, v8
    v_lshl_add_u32 v8, v4, 3, v8
    v_add_u32 v16, s74, v8
    s_lshl_b32 s11, s5, 6
    v_add_u32 v21, s11, v0
    v_lshlrev_b32 v17, 4, v21
    v_add_u32 v17, 20480, v17
    v_and_b32 v5, 1, v1
    v_mul_u32_u24 v19, 656, v5
    v_lshl_add_u32 v19, v2, 4, v19
    v_add_u32 v19, 162048, v19
    v_lshlrev_b32 v20, 5, v2
    v_lshl_add_u32 v20, v1, 4, v20
    s_lshl_b32 s72, s68, 1
    s_lshr_b32 s11, s5, 2
    s_add_u32 s72, s72, s11
    s_lshl_b32 s72, s72, 11
    s_and_b32 s11, s5, 3
    s_lshl_b32 s11, s11, 8
    s_add_u32 s72, s72, s11
    s_add_u32 s72, s72, 6094848
    v_mov_b32 v8, 158848
    v_mov_b32 v9, 0
    ds_write_b32 v8, v9 offset:4
    ds_write_b32 v8, v9 offset:20
    s_add_u32 m0, s75, 32768
    s_mov_b32 s12, 196608
    buffer_load_dwordx4 v10, s[44:47], s12 offen nt lds
    s_add_u32 m0, s75, 34816
    s_mov_b32 s12, 245760
    buffer_load_dwordx4 v10, s[44:47], s12 offen nt lds
    s_add_u32 m0, s75, 36864
    s_mov_b32 s12, 294912
    buffer_load_dwordx4 v10, s[44:47], s12 offen nt lds
    s_add_u32 m0, s75, 38912
    s_mov_b32 s12, 344064
    buffer_load_dwordx4 v10, s[44:47], s12 offen nt lds
    s_add_u32 m0, s75, 65536
    s_mov_b32 s12, 393216
    buffer_load_dwordx4 v10, s[44:47], s12 offen nt lds
    s_add_u32 m0, s75, 67584
    s_mov_b32 s12, 442368
    buffer_load_dwordx4 v10, s[44:47], s12 offen nt lds
    s_add_u32 m0, s75, 69632
    s_mov_b32 s12, 491520
    buffer_load_dwordx4 v10, s[44:47], s12 offen nt lds
    s_add_u32 m0, s75, 71680
    s_mov_b32 s12, 540672
    buffer_load_dwordx4 v10, s[44:47], s12 offen nt lds
    s_add_u32 m0, s75, 98304
    s_mov_b32 s12, 589824
    buffer_load_dwordx4 v10, s[44:47], s12 offen nt lds
    s_add_u32 m0, s75, 100352
    s_mov_b32 s12, 638976
    buffer_load_dwordx4 v10, s[44:47], s12 offen nt lds
    s_add_u32 m0, s75, 102400
    s_mov_b32 s12, 688128
    buffer_load_dwordx4 v10, s[44:47], s12 offen nt lds
    s_add_u32 m0, s75, 104448
    s_mov_b32 s12, 737280
    buffer_load_dwordx4 v10, s[44:47], s12 offen nt lds
    s_waitcnt lgkmcnt(0)
    s_add_u32 s10, s10, 1
    s_waitcnt vmcnt(12)
    s_barrier
    v_add_u32 v8, 0, v16
    v_xor_b32 v9, 32, v8
    ds_read_b64_tr_b16 v[32:33], v8 offset:0
    ds_read_b64_tr_b16 v[34:35], v8 offset:512
    ds_read_b64_tr_b16 v[72:73], v9 offset:0
    ds_read_b64_tr_b16 v[74:75], v9 offset:512
    ds_read_b64_tr_b16 v[36:37], v8 offset:4096
    ds_read_b64_tr_b16 v[38:39], v8 offset:4608
    ds_read_b64_tr_b16 v[76:77], v9 offset:4096
    ds_read_b64_tr_b16 v[78:79], v9 offset:4608
    s_waitcnt lgkmcnt(0)
    s_barrier
    s_cmp_lg_u32 s5, 7
    s_cbranch_scc1 L_cnt_11
    s_lshl_b32 s11, s3, 5
    s_add_u32 s11, s11, s4
    s_lshl_b32 s11, s11, 2
    s_add_u32 s11, s11, 3014656
    v_mov_b32 v4, s11
    s_getreg_b32 s11, hwreg(HW_REG_XCC_ID, 0, 4)
    s_lshl_b32 s11, s11, 28
    s_xor_b32 s11, s11, s10
    v_mov_b32 v5, s11
    s_mov_b64 exec, 1
    buffer_store_dword v5, v4, s[52:55], 0 offen sc1
    s_mov_b64 exec, -1
L_cnt_11:
    s_mov_b32 s12, 8192
    buffer_load_dwordx4 v[122:125], v17, s[52:55], 0 offen sc1
    buffer_load_dwordx4 v[126:129], v17, s[52:55], s12 offen sc1
    s_add_u32 m0, s75, 0
    s_mov_b32 s12, 786432
    buffer_load_dwordx4 v10, s[44:47], s12 offen nt lds
    s_add_u32 m0, s75, 2048
    s_mov_b32 s12, 835584
    buffer_load_dwordx4 v10, s[44:47], s12 offen nt lds
    s_add_u32 m0, s75, 4096
    s_mov_b32 s12, 884736
    buffer_load_dwordx4 v10, s[44:47], s12 offen nt lds
    s_add_u32 m0, s75, 6144
    s_mov_b32 s12, 933888
    buffer_load_dwordx4 v10, s[44:47], s12 offen nt lds
    s_waitcnt vmcnt(14)
    s_barrier
    v_add_u32 v8, 32768, v16
    v_xor_b32 v9, 32, v8
    ds_read_b64_tr_b16 v[40:41], v8 offset:0
    ds_read_b64_tr_b16 v[42:43], v8 offset:512
    ds_read_b64_tr_b16 v[80:81], v9 offset:0
    ds_read_b64_tr_b16 v[82:83], v9 offset:512
    ds_read_b64_tr_b16 v[44:45], v8 offset:4096
    ds_read_b64_tr_b16 v[46:47], v8 offset:4608
    ds_read_b64_tr_b16 v[84:85], v9 offset:4096
    ds_read_b64_tr_b16 v[86:87], v9 offset:4608
    s_waitcnt vmcnt(10)
    s_barrier
    v_add_u32 v8, 65536, v16
    v_xor_b32 v9, 32, v8
    ds_read_b64_tr_b16 v[48:49], v8 offset:0
    ds_read_b64_tr_b16 v[50:51], v8 offset:512
    ds_read_b64_tr_b16 v[88:89], v9 offset:0
    ds_read_b64_tr_b16 v[90:91], v9 offset:512
    ds_read_b64_tr_b16 v[52:53], v8 offset:4096
    ds_read_b64_tr_b16 v[54:55], v8 offset:4608
    ds_read_b64_tr_b16 v[92:93], v9 offset:4096
    ds_read_b64_tr_b16 v[94:95], v9 offset:4608
    s_waitcnt vmcnt(6)
    s_barrier
    v_add_u32 v8, 98304, v16
    v_xor_b32 v9, 32, v8
    ds_read_b64_tr_b16 v[56:57], v8 offset:0
    ds_read_b64_tr_b16 v[58:59], v8 offset:512
    ds_read_b64_tr_b16 v[96:97], v9 offset:0
    ds_read_b64_tr_b16 v[98:99], v9 offset:512
    ds_read_b64_tr_b16 v[60:61], v8 offset:4096
    ds_read_b64_tr_b16 v[62:63], v8 offset:4608
    ds_read_b64_tr_b16 v[100:101], v9 offset:4096
    ds_read_b64_tr_b16 v[102:103], v9 offset:4608
    s_mov_b32 s15, 200000
    s_waitcnt vmcnt(4)
L_sweep:
    v_xor_b32 v5, s10, v123
    v_xor_b32 v6, s10, v125
    v_xor_b32 v7, s10, v127
    v_xor_b32 v8, s10, v129
    v_or3_b32 v5, v5, v6, v7
    v_or_b32 v5, v5, v8
    v_cmp_ne_u32 vcc, 0, v5
    s_cmp_eq_u64 vcc, 0
    s_cbranch_scc1 L_swok
    s_mov_b64 exec, vcc
    s_sub_u32 s15, s15, 1
    s_cmp_eq_u32 s15, 0
    s_cbranch_scc1 L_swok
    s_sleep 4
    s_mov_b32 s12, 8192
    buffer_load_dwordx4 v[122:125], v17, s[52:55], 0 offen sc1
    buffer_load_dwordx4 v[126:129], v17, s[52:55], s12 offen sc1
    s_waitcnt vmcnt(0)
    s_branch L_sweep
L_swok:
    s_mov_b64 exec, -1
    v_max_u32 v5, v122, v124
    v_min_u32 v6, v122, v124
    v_max_u32 v7, v126, v128
    v_min_u32 v8, v126, v128
    v_max_u32 v3, v5, v7
    v_min_u32 v5, v5, v7
    v_max3_u32 v4, v5, v6, v8
    s_nop 0
    v_min_u32_dpp v5, v3, v3 row_ror:8 row_mask:0xf bank_mask:0xf
    v_max_u32_dpp v4, v4, v4 row_ror:8 row_mask:0xf bank_mask:0xf
    v_max_u32_dpp v3, v3, v3 row_ror:8 row_mask:0xf bank_mask:0xf
    v_max_u32 v4, v4, v5
    s_nop 0
    v_min_u32_dpp v5, v3, v3 row_ror:4 row_mask:0xf bank_mask:0xf
    v_max_u32_dpp v4, v4, v4 row_ror:4 row_mask:0xf bank_mask:0xf
    v_max_u32_dpp v3, v3, v3 row_ror:4 row_mask:0xf bank_mask:0xf
    v_max_u32 v4, v4, v5
    s_nop 0
    v_min_u32_dpp v5, v3, v3 row_ror:2 row_mask:0xf bank_mask:0xf
    v_max_u32_dpp v4, v4, v4 row_ror:2 row_mask:0xf bank_mask:0xf
    v_max_u32_dpp v3, v3, v3 row_ror:2 row_mask:0xf bank_mask:0xf
    v_max_u32 v4, v4, v5
    s_nop 0
    v_min_u32_dpp v5, v3, v3 row_ror:1 row_mask:0xf bank_mask:0xf
    v_max_u32_dpp v4, v4, v4 row_ror:1 row_mask:0xf bank_mask:0xf
    v_max_u32_dpp v3, v3, v3 row_ror:1 row_mask:0xf bank_mask:0xf
    v_max_u32 v4, v4, v5
    s_lshl_b32 s11, s5, 5
    s_add_u32 s11, s11, 157952
    v_lshl_add_u32 v7, v2, 3, s11
    v_mov_b32 v8, v3
    v_mov_b32 v9, v4
    ds_write_b64 v7, v[8:9]
    v_lshlrev_b32 v7, 4, v1
    v_add_u32 v7, 157952, v7
    s_waitcnt lgkmcnt(0)
    s_barrier
    s_cmp_ge_u32 s5, 3
    s_cbranch_scc1 L_noxn
    ds_read_b128 v[122:125], v7
    s_waitcnt lgkmcnt(0)
    v_max_u32 v3, v122, v124
    v_min_u32 v5, v122, v124
    v_max3_u32 v4, v5, v123, v125
    s_nop 0
    v_min_u32_dpp v5, v3, v3 row_ror:8 row_mask:0xf bank_mask:0xf
    v_max_u32_dpp v4, v4, v4 row_ror:8 row_mask:0xf bank_mask:0xf
    v_max_u32_dpp v3, v3, v3 row_ror:8 row_mask:0xf bank_mask:0xf
    v_max_u32 v4, v4, v5
    s_nop 0
    v_min_u32_dpp v5, v3, v3 row_ror:4 row_mask:0xf bank_mask:0xf
    v_max_u32_dpp v4, v4, v4 row_ror:4 row_mask:0xf bank_mask:0xf
    v_max_u32_dpp v3, v3, v3 row_ror:4 row_mask:0xf bank_mask:0xf
    v_max_u32 v4, v4, v5
    s_nop 0
    v_min_u32_dpp v5, v3, v3 row_ror:2 row_mask:0xf bank_mask:0xf
    v_max_u32_dpp v4, v4, v4 row_ror:2 row_mask:0xf bank_mask:0xf
    v_max_u32_dpp v3, v3, v3 row_ror:2 row_mask:0xf bank_mask:0xf
    v_max_u32 v4, v4, v5
    s_nop 0
    v_min_u32_dpp v5, v3, v3 row_ror:1 row_mask:0xf bank_mask:0xf
    v_max_u32_dpp v4, v4, v4 row_ror:1 row_mask:0xf bank_mask:0xf
    v_max_u32_dpp v3, v3, v3 row_ror:1 row_mask:0xf bank_mask:0xf
    v_max_u32 v4, v4, v5
    v_readfirstlane_b32 s76, v3
    v_readfirstlane_b32 s77, v4
    s_cmp_lg_u32 s5, 2
    s_cbranch_scc1 L_rx
    s_cmp_lg_u32 s68, 0
    s_cbranch_scc1 L_noxn
    v_mov_b32 v4, s76
    v_mov_b32 v5, s10
    v_mov_b32 v6, s77
    v_mov_b32 v7, s10
    v_mov_b32 v3, 0
    s_mov_b64 exec, 1
    buffer_store_dwordx4 v[4:7], v3, s[52:55], 0 offen offset:256 sc1
    s_mov_b64 exec, -1
    s_branch L_noxn
L_rx:
    s_cmp_eq_u32 s5, 0
    s_cselect_b32 s11, s76, s77
    s_and_b32 s11, s11, 0xffff
    s_sub_u32 s11, 2047, s11
    s_lshl_b32 s13, s11, 3
    s_add_u32 s13, s13, 4096
    s_mul_i32 s11, s11, 1280
    s_and_b32 s12, s68, 1
    s_mul_i32 s12, s12, 640
    s_add_u32 s11, s11, s12
    s_mul_i32 s12, s5, 656
    s_add_u32 s12, s12, 162048
    v_add_u32 v9, s12, v254
    v_mov_b32 v7, 0
    s_mov_b32 exec_hi, 0xff
    s_mov_b32 s15, 200000
    buffer_load_dwordx4 v[122:125], v254, s[40:43], s11 offen
L_rst:
    buffer_load_dwordx2 v[126:127], v7, s[52:55], s13 offen sc1
    s_waitcnt vmcnt(0)
    v_cmp_ne_u32 vcc, s10, v127
    s_cmp_eq_u64 vcc, 0
    s_cbranch_scc1 L_rstok
    s_sub_u32 s15, s15, 1
    s_cmp_lg_u32 s15, 0
    s_cbranch_scc1 L_rst
L_rstok:
    v_and_b32 v3, 0xffff0000, v126
    v_rcp_f32 v3, v3
    v_lshlrev_b32 v4, 16, v126
    v_lshlrev_b32 v128, 16, v122
    v_and_b32 v129, 0xffff0000, v122
    v_lshlrev_b32 v130, 16, v123
    v_and_b32 v131, 0xffff0000, v123
    v_lshlrev_b32 v132, 16, v124
    v_and_b32 v133, 0xffff0000, v124
    v_lshlrev_b32 v134, 16, v125
    v_and_b32 v135, 0xffff0000, v125
    v_sub_f32 v128, v128, v4
    v_sub_f32 v129, v129, v4
    v_sub_f32 v130, v130, v4
    v_sub_f32 v131, v131, v4
    v_sub_f32 v132, v132, v4
    v_sub_f32 v133, v133, v4
    v_sub_f32 v134, v134, v4
    v_sub_f32 v135, v135, v4
    v_cvt_pk_bf16_f32 v122, v128, v129
    v_cvt_pk_bf16_f32 v123, v130, v131
    v_cvt_pk_bf16_f32 v124, v132, v133
    v_cvt_pk_bf16_f32 v125, v134, v135
    v_lshlrev_b32 v128, 16, v122
    v_and_b32 v129, 0xffff0000, v122
    v_lshlrev_b32 v130, 16, v123
    v_and_b32 v131, 0xffff0000, v123
    v_lshlrev_b32 v132, 16, v124
    v_and_b32 v133, 0xffff0000, v124
    v_lshlrev_b32 v134, 16, v125
    v_and_b32 v135, 0xffff0000, v125
    v_mul_f32 v128, v128, v3
    v_mul_f32 v129, v129, v3
    v_mul_f32 v130, v130, v3
    v_mul_f32 v131, v131, v3
    v_mul_f32 v132, v132, v3
    v_mul_f32 v133, v133, v3
    v_mul_f32 v134, v134, v3
    v_mul_f32 v135, v135, v3
    v_cvt_pk_bf16_f32 v122, v128, v129
    v_cvt_pk_bf16_f32 v123, v130, v131
    v_cvt_pk_bf16_f32 v124, v132, v133
    v_cvt_pk_bf16_f32 v125, v134, v135
    ds_write_b128 v9, v[122:125]
    s_mov_b64 exec, -1
L_noxn:
    s_waitcnt lgkmcnt(0)
    s_waitcnt vmcnt(0)
    s_barrier
    v_add_u32 v8, 0, v16
    v_xor_b32 v9, 32, v8
    ds_read_b64_tr_b16 v[64:65], v8 offset:0
    ds_read_b64_tr_b16 v[66:67], v8 offset:512
    ds_read_b64_tr_b16 v[104:105], v9 offset:0
    ds_read_b64_tr_b16 v[106:107], v9 offset:512
    ds_read_b64_tr_b16 v[68:69], v8 offset:4096
    ds_read_b64_tr_b16 v[70:71], v8 offset:4608
    ds_read_b64_tr_b16 v[108:109], v9 offset:4096
    ds_read_b64_tr_b16 v[110:111], v9 offset:4608
    s_waitcnt lgkmcnt(0)
    ds_read_b128 v[112:115], v19 offset:0
    ds_read_b128 v[116:119], v19 offset:64
    ds_read_b128 v[120:123], v19 offset:128
    ds_read_b128 v[124:127], v19 offset:192
    ds_read_b128 v[128:131], v19 offset:256
    ds_read_b128 v[132:135], v19 offset:320
    ds_read_b128 v[136:139], v19 offset:384
    ds_read_b128 v[140:143], v19 offset:448
    ds_read_b128 v[144:147], v19 offset:512
    ds_read_b128 v[148:151], v19 offset:576
    v_mov_b32 v170, s10
    v_mov_b32 v171, 0
    v_mov_b32 v174, s10
    v_mov_b32 v175, 0
    v_mov_b32 v178, s10
    v_mov_b32 v179, 0
    v_mov_b32 v182, s10
    v_mov_b32 v183, 0
    s_waitcnt lgkmcnt(9)
    v_mfma_f32_16x16x32_bf16 v[160:163], v[32:35], v[112:115], 0
    v_mfma_f32_16x16x32_bf16 v[164:167], v[72:75], v[112:115], 0
    s_waitcnt lgkmcnt(8)
    v_mfma_f32_16x16x32_bf16 v[160:163], v[36:39], v[116:119], v[160:163]
    v_mfma_f32_16x16x32_bf16 v[164:167], v[76:79], v[116:119], v[164:167]
    s_waitcnt lgkmcnt(7)
    v_mfma_f32_16x16x32_bf16 v[160:163], v[40:43], v[120:123], v[160:163]
    v_mfma_f32_16x16x32_bf16 v[164:167], v[80:83], v[120:123], v[164:167]
    s_waitcnt lgkmcnt(6)
    v_mfma_f32_16x16x32_bf16 v[160:163], v[44:47], v[124:127], v[160:163]
    v_mfma_f32_16x16x32_bf16 v[164:167], v[84:87], v[124:127], v[164:167]
    s_waitcnt lgkmcnt(5)
    v_mfma_f32_16x16x32_bf16 v[160:163], v[48:51], v[128:131], v[160:163]
    v_mfma_f32_16x16x32_bf16 v[164:167], v[88:91], v[128:131], v[164:167]
    s_waitcnt lgkmcnt(4)
    v_mfma_f32_16x16x32_bf16 v[160:163], v[52:55], v[132:135], v[160:163]
    v_mfma_f32_16x16x32_bf16 v[164:167], v[92:95], v[132:135], v[164:167]
    s_waitcnt lgkmcnt(3)
    v_mfma_f32_16x16x32_bf16 v[160:163], v[56:59], v[136:139], v[160:163]
    v_mfma_f32_16x16x32_bf16 v[164:167], v[96:99], v[136:139], v[164:167]
    s_waitcnt lgkmcnt(2)
    v_mfma_f32_16x16x32_bf16 v[160:163], v[60:63], v[140:143], v[160:163]
    v_mfma_f32_16x16x32_bf16 v[164:167], v[100:103], v[140:143], v[164:167]
    s_waitcnt lgkmcnt(1)
    v_mfma_f32_16x16x32_bf16 v[160:163], v[64:67], v[144:147], v[160:163]
    v_mfma_f32_16x16x32_bf16 v[164:167], v[104:107], v[144:147], v[164:167]
    s_waitcnt lgkmcnt(0)
    v_mfma_f32_16x16x32_bf16 v[160:163], v[68:71], v[148:151], v[160:163]
    v_mfma_f32_16x16x32_bf16 v[164:167], v[108:111], v[148:151], v[164:167]
    v_cmp_gt_u32 vcc, 2, v1
    s_and_b64 exec, exec, vcc
    s_nop 4
    v_mov_b32 v168, v160
    v_mov_b32 v169, v161
    buffer_store_dwordx4 v[168:171], v20, s[52:55], s72 offen offset:0 sc1
    v_mov_b32 v172, v162
    v_mov_b32 v173, v163
    buffer_store_dwordx4 v[172:175], v20, s[52:55], s72 offen offset:1024 sc1
    v_mov_b32 v176, v164
    v_mov_b32 v177, v165
    buffer_store_dwordx4 v[176:179], v20, s[52:55], s72 offen offset:128 sc1
    v_mov_b32 v180, v166
    v_mov_b32 v181, v167
    buffer_store_dwordx4 v[180:183], v20, s[52:55], s72 offen offset:1152 sc1
    s_mov_b64 exec, -1
    s_barrier
L_woall:
    s_add_u32 s12, s5, s70
    s_cmp_ge_u32 s12, 20
    s_cselect_b32 s13, 20, 0
    s_sub_u32 s12, s12, s13
    s_mul_i32 s12, s12, 40960
    s_mul_i32 s13, s5, 5120
    s_add_u32 s13, s13, 55552
    s_add_u32 m0, s13, 0
    s_nop 0
    buffer_load_dwordx4 v11, s[48:51], s12 offen lds
    s_add_u32 m0, s13, 1024
    s_nop 0
    buffer_load_dwordx4 v12, s[48:51], s12 offen lds
    s_add_u32 m0, s13, 2048
    s_nop 0
    buffer_load_dwordx4 v13, s[48:51], s12 offen lds
    s_add_u32 m0, s13, 3072
    s_nop 0
    buffer_load_dwordx4 v14, s[48:51], s12 offen lds
    s_add_u32 m0, s13, 4096
    s_nop 0
    buffer_load_dwordx4 v15, s[48:51], s12 offen lds
    s_add_u32 s71, s5, 8
    s_add_u32 s12, s71, s70
    s_cmp_ge_u32 s12, 20
    s_cselect_b32 s13, 20, 0
    s_sub_u32 s12, s12, s13
    s_mul_i32 s12, s12, 40960
    s_mul_i32 s13, s71, 5120
    s_add_u32 s13, s13, 55552
    s_add_u32 m0, s13, 0
    s_nop 0
    buffer_load_dwordx4 v11, s[48:51], s12 offen lds
    s_add_u32 m0, s13, 1024
    s_nop 0
    buffer_load_dwordx4 v12, s[48:51], s12 offen lds
    s_add_u32 m0, s13, 2048
    s_nop 0
    buffer_load_dwordx4 v13, s[48:51], s12 offen lds
    s_add_u32 m0, s13, 3072
    s_nop 0
    buffer_load_dwordx4 v14, s[48:51], s12 offen lds
    s_add_u32 m0, s13, 4096
    s_nop 0
    buffer_load_dwordx4 v15, s[48:51], s12 offen lds
    s_cmp_lt_u32 s5, 4
    s_cbranch_scc1 L_p2wo
    s_add_u32 s71, s5, 12
    s_add_u32 s12, s71, s70
    s_cmp_ge_u32 s12, 20
    s_cselect_b32 s13, 20, 0
    s_sub_u32 s12, s12, s13
    s_mul_i32 s12, s12, 40960
    s_mul_i32 s13, s71, 5120
    s_add_u32 s13, s13, 55552
    s_add_u32 m0, s13, 0
    s_nop 0
    buffer_load_dwordx4 v11, s[48:51], s12 offen lds
    s_add_u32 m0, s13, 1024
    s_nop 0
    buffer_load_dwordx4 v12, s[48:51], s12 offen lds
    s_add_u32 m0, s13, 2048
    s_nop 0
    buffer_load_dwordx4 v13, s[48:51], s12 offen lds
    s_add_u32 m0, s13, 3072
    s_nop 0
    buffer_load_dwordx4 v14, s[48:51], s12 offen lds
    s_add_u32 m0, s13, 4096
    s_nop 0
    buffer_load_dwordx4 v15, s[48:51], s12 offen lds
    s_branch L_p2wo
L_down2:
    s_load_dword s10, s[36:37], 0
    s_mov_b32 s40, s16
    s_mov_b32 s41, s17
    s_mov_b32 s42, 2621440
    s_mov_b32 s43, 0x20000
    s_mov_b32 s52, s36
    s_mov_b32 s53, s37
    s_mov_b32 s54, 11534336
    s_mov_b32 s55, 0x20000
    s_lshl_b32 s60, s3, 2
    s_and_b32 s11, s4, 3
    s_add_u32 s60, s60, s11
    s_lshl_b32 s60, s60, 2
    s_and_b32 s12, s5, 3
    s_add_u32 s60, s60, s12
    s_lshr_b32 s61, s5, 2
    s_xor_b32 s61, s61, s3
    s_and_b32 s61, s61, 1
    s_lshr_b32 s62, s4, 2
    s_mul_i32 s62, s62, 80
    s_mov_b32 s38, 0
    v_and_b32 v100, 15, v0
    v_lshrrev_b32 v101, 4, v0
    s_lshl_b32 s12, s60, 4
    v_add_u32 v102, s12, v100
    v_lshlrev_b32 v235, 3, v102
    v_add_u32 v235, 4096, v235
    v_mul_u32_u24 v102, 1280, v102
    v_lshl_add_u32 v102, v101, 3, v102
    s_lshl_b32 s12, s62, 1
    v_add_u32 v234, s12, v102
    v_lshlrev_b32 v254, 4, v0
    v_and_b32 v102, 1, v101
    v_mul_u32_u24 v102, 24, v102
    v_add_u32 v233, v234, v102
    v_lshrrev_b32 v102, 2, v0
    v_and_b32 v103, 3, v0
    v_mul_u32_u24 v102, 160, v102
    v_lshl_add_u32 v102, v103, 3, v102
    s_xor_b32 s12, s61, s11
    s_and_b32 s12, s12, 1
    s_mul_i32 s12, s12, 51200
    s_add_u32 s12, s12, 55552
    v_add_u32 v244, s12, v102
    v_add_u32 v103, 10240, v244
    v_cmp_gt_u32 vcc, 16, v0
    s_nop 1
    v_cndmask_b32 v245, v244, v103, vcc
    v_cmp_gt_u32 vcc, 32, v0
    s_nop 1
    v_cndmask_b32 v246, v244, v103, vcc
    v_cmp_gt_u32 vcc, 48, v0
    s_nop 1
    v_cndmask_b32 v247, v244, v103, vcc
    s_mov_b32 s56, s32
    s_mov_b32 s57, s33
    s_mov_b32 s58, 2621440
    s_mov_b32 s59, 0x20000
    s_mul_i32 s12, s60, 10
    s_mul_i32 s11, s61, 5
    s_add_u32 s12, s12, s11
    s_lshl_b32 s63, s12, 7
    s_add_u32 s63, s63, 2818048
    s_and_b32 s11, s5, 3
    s_mul_i32 s11, s11, 9920
    s_add_u32 s11, s11, 160
    v_mul_u32_u24 v101, 240, v101
    v_add3_u32 v232, v101, v254, s11
    s_lshl_b32 s22, s12, 11
    s_add_u32 s22, s22, 3145728
    s_add_u32 s23, s22, 4096
    s_add_u32 s24, s22, 8192
    s_cmp_ge_u32 s60, 36
    s_cselect_b32 s11, 1, 0
    s_cmpk_ge_u32 s60, 66
    s_addc_u32 s11, s11, 0
    s_cmpk_ge_u32 s60, 102
    s_addc_u32 s11, s11, 0
    s_lshl_b32 s11, s11, 1
    s_add_u32 s11, s11, s61
    s_cmp_eq_u32 s11, s3
    s_cselect_b32 s100, 1, 0
    s_mov_b32 s48, s20
    s_mov_b32 s49, s21
    s_mov_b32 s50, 819200
    s_mov_b32 s51, 0x20000
    s_lshr_b32 s11, s4, 2
    s_mul_i32 s11, s11, 160
    s_and_b32 s70, s4, 1
    s_mul_i32 s70, s70, 10
    v_add_u32 v2, 0, v0
    v_mul_u32_u24 v3, 6554, v2
    v_lshrrev_b32 v3, 16, v3
    v_mul_u32_u24 v4, 10, v3
    v_sub_u32 v4, v2, v4
    v_mul_u32_u24 v3, 1280, v3
    v_lshl_add_u32 v3, v4, 4, v3
    v_add_u32 v11, s11, v3
    v_add_u32 v2, 64, v0
    v_mul_u32_u24 v3, 6554, v2
    v_lshrrev_b32 v3, 16, v3
    v_mul_u32_u24 v4, 10, v3
    v_sub_u32 v4, v2, v4
    v_mul_u32_u24 v3, 1280, v3
    v_lshl_add_u32 v3, v4, 4, v3
    v_add_u32 v12, s11, v3
    v_add_u32 v2, 128, v0
    v_mul_u32_u24 v3, 6554, v2
    v_lshrrev_b32 v3, 16, v3
    v_mul_u32_u24 v4, 10, v3
    v_sub_u32 v4, v2, v4
    v_mul_u32_u24 v3, 1280, v3
    v_lshl_add_u32 v3, v4, 4, v3
    v_add_u32 v13, s11, v3
    v_add_u32 v2, 192, v0
    v_mul_u32_u24 v3, 6554, v2
    v_lshrrev_b32 v3, 16, v3
    v_mul_u32_u24 v4, 10, v3
    v_sub_u32 v4, v2, v4
    v_mul_u32_u24 v3, 1280, v3
    v_lshl_add_u32 v3, v4, 4, v3
    v_add_u32 v14, s11, v3
    v_add_u32 v2, 256, v0
    v_mul_u32_u24 v3, 6554, v2
    v_lshrrev_b32 v3, 16, v3
    v_mul_u32_u24 v4, 10, v3
    v_sub_u32 v4, v2, v4
    v_mul_u32_u24 v3, 1280, v3
    v_lshl_add_u32 v3, v4, 4, v3
    v_add_u32 v15, s11, v3
    v_and_b32 v1, 15, v0
    v_lshrrev_b32 v2, 4, v0
    v_lshrrev_b32 v3, 2, v1
    v_and_b32 v4, 3, v1
    v_and_b32 v6, 1, v2
    v_lshl_add_u32 v7, v2, 3, v3
    v_lshl_or_b32 v5, v6, 2, v3
    v_mul_u32_u24 v7, 1280, v7
    v_lshl_add_u32 v7, v4, 3, v7
    s_mul_i32 s11, s5, 5
    s_add_u32 s12, s11, 0
    v_xor_b32 v8, s12, v5
    v_lshl_add_u32 v18, v8, 5, v7
    s_add_u32 s12, s11, 1
    v_xor_b32 v8, s12, v5
    v_lshl_add_u32 v19, v8, 5, v7
    s_add_u32 s12, s11, 2
    v_xor_b32 v8, s12, v5
    v_lshl_add_u32 v20, v8, 5, v7
    s_add_u32 s12, s11, 3
    v_xor_b32 v8, s12, v5
    v_lshl_add_u32 v21, v8, 5, v7
    s_add_u32 s12, s11, 4
    v_xor_b32 v8, s12, v5
    v_lshl_add_u32 v22, v8, 5, v7
    v_mov_b32 v8, 158848
    v_mov_b32 v9, 0
    ds_write_b32 v8, v9 offset:4
    ds_write_b32 v8, v9 offset:20
    s_add_u32 m0, s72, 40960
    s_add_u32 s12, s73, 40960
    buffer_load_dwordx4 v26, s[64:67], s12 offen nt lds
    s_add_u32 m0, s72, 41984
    s_add_u32 s12, s73, 40960
    buffer_load_dwordx4 v27, s[64:67], s12 offen nt lds
    s_add_u32 m0, s72, 43008
    s_add_u32 s12, s73, 40960
    buffer_load_dwordx4 v28, s[64:67], s12 offen nt lds
    s_add_u32 m0, s72, 44032
    s_add_u32 s12, s73, 40960
    buffer_load_dwordx4 v29, s[64:67], s12 offen nt lds
    s_add_u32 m0, s72, 45056
    s_add_u32 s12, s73, 40960
    buffer_load_dwordx4 v30, s[64:67], s12 offen nt lds
    s_add_u32 m0, s72, 81920
    s_add_u32 s12, s73, 81920
    buffer_load_dwordx4 v26, s[64:67], s12 offen nt lds
    s_add_u32 m0, s72, 82944
    s_add_u32 s12, s73, 81920
    buffer_load_dwordx4 v27, s[64:67], s12 offen nt lds
    s_add_u32 m0, s72, 83968
    s_add_u32 s12, s73, 81920
    buffer_load_dwordx4 v28, s[64:67], s12 offen nt lds
    s_add_u32 m0, s72, 84992
    s_add_u32 s12, s73, 81920
    buffer_load_dwordx4 v29, s[64:67], s12 offen nt lds
    s_add_u32 m0, s72, 86016
    s_add_u32 s12, s73, 81920
    buffer_load_dwordx4 v30, s[64:67], s12 offen nt lds
    s_waitcnt lgkmcnt(0)
    s_add_u32 s10, s10, 1
    s_waitcnt vmcnt(10)
    s_barrier
    v_add_u32 v8, 0, v18
    ds_read_b64_tr_b16 v[32:33], v8 offset:0
    ds_read_b64_tr_b16 v[34:35], v8 offset:5120
    v_add_u32 v8, 0, v19
    ds_read_b64_tr_b16 v[36:37], v8 offset:0
    ds_read_b64_tr_b16 v[38:39], v8 offset:5120
    v_add_u32 v8, 0, v20
    ds_read_b64_tr_b16 v[40:41], v8 offset:0
    ds_read_b64_tr_b16 v[42:43], v8 offset:5120
    v_add_u32 v8, 0, v21
    ds_read_b64_tr_b16 v[44:45], v8 offset:0
    ds_read_b64_tr_b16 v[46:47], v8 offset:5120
    v_add_u32 v8, 0, v22
    ds_read_b64_tr_b16 v[48:49], v8 offset:0
    ds_read_b64_tr_b16 v[50:51], v8 offset:5120
    s_waitcnt lgkmcnt(0)
    s_barrier
    s_cmp_lg_u32 s5, 7
    s_cbranch_scc1 L_cnt_12
    s_lshl_b32 s11, s3, 5
    s_add_u32 s11, s11, s4
    s_lshl_b32 s11, s11, 2
    s_add_u32 s11, s11, 3014656
    v_mov_b32 v4, s11
    s_getreg_b32 s11, hwreg(HW_REG_XCC_ID, 0, 4)
    s_lshl_b32 s11, s11, 28
    s_xor_b32 s11, s11, s10
    v_mov_b32 v5, s11
    s_mov_b64 exec, 1
    buffer_store_dword v5, v4, s[52:55], 0 offen sc1
    s_mov_b64 exec, -1
L_cnt_12:
    s_add_u32 m0, s72, 0
    s_add_u32 s12, s73, 122880
    buffer_load_dwordx4 v26, s[64:67], s12 offen nt lds
    s_add_u32 m0, s72, 1024
    s_add_u32 s12, s73, 122880
    buffer_load_dwordx4 v27, s[64:67], s12 offen nt lds
    s_add_u32 m0, s72, 2048
    s_add_u32 s12, s73, 122880
    buffer_load_dwordx4 v28, s[64:67], s12 offen nt lds
    s_add_u32 m0, s72, 3072
    s_add_u32 s12, s73, 122880
    buffer_load_dwordx4 v29, s[64:67], s12 offen nt lds
    s_add_u32 m0, s72, 4096
    s_add_u32 s12, s73, 122880
    buffer_load_dwordx4 v30, s[64:67], s12 offen nt lds
    s_waitcnt vmcnt(10)
    s_barrier
    v_add_u32 v8, 40960, v18
    ds_read_b64_tr_b16 v[52:53], v8 offset:0
    ds_read_b64_tr_b16 v[54:55], v8 offset:5120
    v_add_u32 v8, 40960, v19
    ds_read_b64_tr_b16 v[56:57], v8 offset:0
    ds_read_b64_tr_b16 v[58:59], v8 offset:5120
    v_add_u32 v8, 40960, v20
    ds_read_b64_tr_b16 v[60:61], v8 offset:0
    ds_read_b64_tr_b16 v[62:63], v8 offset:5120
    v_add_u32 v8, 40960, v21
    ds_read_b64_tr_b16 v[64:65], v8 offset:0
    ds_read_b64_tr_b16 v[66:67], v8 offset:5120
    v_add_u32 v8, 40960, v22
    ds_read_b64_tr_b16 v[68:69], v8 offset:0
    ds_read_b64_tr_b16 v[70:71], v8 offset:5120
    s_waitcnt vmcnt(5)
    s_barrier
    v_add_u32 v8, 81920, v18
    ds_read_b64_tr_b16 v[72:73], v8 offset:0
    ds_read_b64_tr_b16 v[74:75], v8 offset:5120
    v_add_u32 v8, 81920, v19
    ds_read_b64_tr_b16 v[76:77], v8 offset:0
    ds_read_b64_tr_b16 v[78:79], v8 offset:5120
    v_add_u32 v8, 81920, v20
    ds_read_b64_tr_b16 v[80:81], v8 offset:0
    ds_read_b64_tr_b16 v[82:83], v8 offset:5120
    v_add_u32 v8, 81920, v21
    ds_read_b64_tr_b16 v[84:85], v8 offset:0
    ds_read_b64_tr_b16 v[86:87], v8 offset:5120
    v_add_u32 v8, 81920, v22
    ds_read_b64_tr_b16 v[88:89], v8 offset:0
    ds_read_b64_tr_b16 v[90:91], v8 offset:5120
    s_waitcnt lgkmcnt(0)
    s_barrier
    s_cmp_eq_u32 s5, 0
    s_cbranch_scc1 L_dn0
    s_sub_u32 s71, s5, 1
    s_add_u32 s12, s71, s70
    s_cmp_ge_u32 s12, 20
    s_cselect_b32 s13, 20, 0
    s_sub_u32 s12, s12, s13
    s_mul_i32 s12, s12, 40960
    s_mul_i32 s13, s71, 5120
    s_add_u32 s13, s13, 55552
    s_add_u32 m0, s13, 0
    s_nop 0
    buffer_load_dwordx4 v11, s[48:51], s12 offen lds
    s_add_u32 m0, s13, 1024
    s_nop 0
    buffer_load_dwordx4 v12, s[48:51], s12 offen lds
    s_add_u32 m0, s13, 2048
    s_nop 0
    buffer_load_dwordx4 v13, s[48:51], s12 offen lds
    s_add_u32 m0, s13, 3072
    s_nop 0
    buffer_load_dwordx4 v14, s[48:51], s12 offen lds
    s_add_u32 m0, s13, 4096
    s_nop 0
    buffer_load_dwordx4 v15, s[48:51], s12 offen lds
    s_waitcnt vmcnt(5)
    s_branch L_dn0b
L_dn0:
    s_waitcnt vmcnt(0)
L_dn0b:
    s_waitcnt vmcnt(63)
    s_barrier
    v_add_u32 v8, 0, v18
    ds_read_b64_tr_b16 v[92:93], v8 offset:0
    ds_read_b64_tr_b16 v[94:95], v8 offset:5120
    v_add_u32 v8, 0, v19
    ds_read_b64_tr_b16 v[96:97], v8 offset:0
    ds_read_b64_tr_b16 v[98:99], v8 offset:5120
    v_add_u32 v8, 0, v20
    ds_read_b64_tr_b16 v[100:101], v8 offset:0
    ds_read_b64_tr_b16 v[102:103], v8 offset:5120
    v_add_u32 v8, 0, v21
    ds_read_b64_tr_b16 v[104:105], v8 offset:0
    ds_read_b64_tr_b16 v[106:107], v8 offset:5120
    v_add_u32 v8, 0, v22
    ds_read_b64_tr_b16 v[108:109], v8 offset:0
    ds_read_b64_tr_b16 v[110:111], v8 offset:5120
    s_cmp_eq_u32 s5, 0
    s_cbranch_scc1 L_dn1
    s_add_u32 s71, s5, 6
    s_add_u32 s12, s71, s70
    s_cmp_ge_u32 s12, 20
    s_cselect_b32 s13, 20, 0
    s_sub_u32 s12, s12, s13
    s_mul_i32 s12, s12, 40960
    s_mul_i32 s13, s71, 5120
    s_add_u32 s13, s13, 55552
    s_add_u32 m0, s13, 0
    s_nop 0
    buffer_load_dwordx4 v11, s[48:51], s12 offen lds
    s_add_u32 m0, s13, 1024
    s_nop 0
    buffer_load_dwordx4 v12, s[48:51], s12 offen lds
    s_add_u32 m0, s13, 2048
    s_nop 0
    buffer_load_dwordx4 v13, s[48:51], s12 offen lds
    s_add_u32 m0, s13, 3072
    s_nop 0
    buffer_load_dwordx4 v14, s[48:51], s12 offen lds
    s_add_u32 m0, s13, 4096
    s_nop 0
    buffer_load_dwordx4 v15, s[48:51], s12 offen lds
    s_cmp_eq_u32 s5, 7
    s_cbranch_scc1 L_dn2
    s_add_u32 s71, s5, 13
    s_add_u32 s12, s71, s70
    s_cmp_ge_u32 s12, 20
    s_cselect_b32 s13, 20, 0
    s_sub_u32 s12, s12, s13
    s_mul_i32 s12, s12, 40960
    s_mul_i32 s13, s71, 5120
    s_add_u32 s13, s13, 55552
    s_add_u32 m0, s13, 0
    s_nop 0
    buffer_load_dwordx4 v11, s[48:51], s12 offen lds
    s_add_u32 m0, s13, 1024
    s_nop 0
    buffer_load_dwordx4 v12, s[48:51], s12 offen lds
    s_add_u32 m0, s13, 2048
    s_nop 0
    buffer_load_dwordx4 v13, s[48:51], s12 offen lds
    s_add_u32 m0, s13, 3072
    s_nop 0
    buffer_load_dwordx4 v14, s[48:51], s12 offen lds
    s_add_u32 m0, s13, 4096
    s_nop 0
    buffer_load_dwordx4 v15, s[48:51], s12 offen lds
    s_branch L_dn2
L_dn1:
    s_setprio 3
    s_lshl_b32 s12, s68, 13
    s_add_u32 s12, s12, 6094848
    s_add_u32 s13, s12, 4096
    s_mov_b32 s15, 200000
    s_nop 0
    s_mov_b64 exec, 1
L_hp0:
    buffer_load_dwordx4 v[132:135], v254, s[52:55], s12 offen sc1
    buffer_load_dwordx4 v[136:139], v254, s[52:55], s13 offen sc1
    s_waitcnt vmcnt(0)
    v_xor_b32 v4, s10, v134
    v_xor_b32 v5, s10, v138
    v_or_b32 v3, v4, v5
    v_cmp_ne_u32 vcc, 0, v3
    s_cmp_eq_u64 vcc, 0
    s_cbranch_scc1 L_hp1
    s_sleep 2
    s_sub_u32 s15, s15, 1
    s_cmp_lg_u32 s15, 0
    s_cbranch_scc1 L_hp0
L_hp1:
    s_mov_b64 exec, -1
    s_mov_b32 s15, 200000
L_hp:
    buffer_load_dwordx4 v[132:135], v254, s[52:55], s12 offen offset:0 sc1
    buffer_load_dwordx4 v[136:139], v254, s[52:55], s12 offen offset:1024 sc1
    buffer_load_dwordx4 v[140:143], v254, s[52:55], s12 offen offset:2048 sc1
    buffer_load_dwordx4 v[144:147], v254, s[52:55], s12 offen offset:3072 sc1
    buffer_load_dwordx4 v[148:151], v254, s[52:55], s13 offen offset:0 sc1
    buffer_load_dwordx4 v[152:155], v254, s[52:55], s13 offen offset:1024 sc1
    buffer_load_dwordx4 v[156:159], v254, s[52:55], s13 offen offset:2048 sc1
    buffer_load_dwordx4 v[160:163], v254, s[52:55], s13 offen offset:3072 sc1
    s_waitcnt vmcnt(0)
    v_mov_b32 v3, 0
    v_xor_b32 v4, s10, v134
    v_xor_b32 v5, s10, v138
    v_or3_b32 v3, v3, v4, v5
    v_xor_b32 v4, s10, v142
    v_xor_b32 v5, s10, v146
    v_or3_b32 v3, v3, v4, v5
    v_xor_b32 v4, s10, v150
    v_xor_b32 v5, s10, v154
    v_or3_b32 v3, v3, v4, v5
    v_xor_b32 v4, s10, v158
    v_xor_b32 v5, s10, v162
    v_or3_b32 v3, v3, v4, v5
    v_cmp_ne_u32 vcc, 0, v3
    s_cmp_eq_u64 vcc, 0
    s_cbranch_scc1 L_hok
    s_mov_b64 exec, vcc
    s_sleep 2
    s_sub_u32 s15, s15, 1
    s_cmp_lg_u32 s15, 0
    s_cbranch_scc1 L_hp
L_hok:
    s_mov_b64 exec, -1
    v_pk_add_f32 v[132:133], v[132:133], v[148:149]
    v_pk_add_f32 v[136:137], v[136:137], v[152:153]
    v_pk_add_f32 v[140:141], v[140:141], v[156:157]
    v_pk_add_f32 v[144:145], v[144:145], v[160:161]
    v_cvt_pk_bf16_f32 v4, v132, v133
    v_cvt_pk_bf16_f32 v5, v136, v137
    v_cvt_pk_bf16_f32 v6, v140, v141
    v_cvt_pk_bf16_f32 v7, v144, v145
    v_lshlrev_b32 v132, 16, v4
    v_and_b32 v133, 0xffff0000, v4
    v_lshlrev_b32 v134, 16, v5
    v_and_b32 v135, 0xffff0000, v5
    v_lshlrev_b32 v136, 16, v6
    v_and_b32 v137, 0xffff0000, v6
    v_lshlrev_b32 v138, 16, v7
    v_and_b32 v139, 0xffff0000, v7
    v_mul_f32 v140, 0xbfb8aa3b, v132
    v_mul_f32 v141, 0xbfb8aa3b, v133
    v_mul_f32 v142, 0xbfb8aa3b, v134
    v_mul_f32 v143, 0xbfb8aa3b, v135
    v_exp_f32 v140, v140
    v_exp_f32 v141, v141
    v_exp_f32 v142, v142
    v_exp_f32 v143, v143
    v_add_f32 v140, 1.0, v140
    v_add_f32 v141, 1.0, v141
    v_add_f32 v142, 1.0, v142
    v_add_f32 v143, 1.0, v143
    v_rcp_f32 v140, v140
    v_rcp_f32 v141, v141
    v_rcp_f32 v142, v142
    v_rcp_f32 v143, v143
    v_mul_f32 v132, v132, v140
    v_mul_f32 v133, v133, v141
    v_mul_f32 v134, v134, v142
    v_mul_f32 v135, v135, v143
    v_cvt_pk_bf16_f32 v4, v132, v133
    v_cvt_pk_bf16_f32 v5, v134, v135
    v_lshlrev_b32 v132, 16, v4
    v_and_b32 v133, 0xffff0000, v4
    v_lshlrev_b32 v134, 16, v5
    v_and_b32 v135, 0xffff0000, v5
    v_mul_f32 v132, v132, v136
    v_mul_f32 v133, v133, v137
    v_mul_f32 v134, v134, v138
    v_mul_f32 v135, v135, v139
    v_cvt_pk_bf16_f32 v24, v132, v133
    v_cvt_pk_bf16_f32 v25, v134, v135
    v_and_b32 v3, 1, v0
    v_lshrrev_b32 v4, 1, v0
    v_lshlrev_b32 v3, 8, v3
    v_lshl_add_u32 v3, v4, 3, v3
    v_add_u32 v3, 158336, v3
    ds_write_b64 v3, v[24:25]
L_dn2:
    v_and_b32 v5, 1, v1
    v_lshlrev_b32 v6, 8, v5
    v_lshl_add_u32 v6, v2, 4, v6
    v_add_u32 v6, 158336, v6
    v_lshlrev_b32 v7, 5, v2
    v_lshl_add_u32 v7, v1, 4, v7
    s_mul_i32 s11, s68, 10240
    s_mul_i32 s12, s5, 1280
    s_add_u32 s11, s11, s12
    s_add_u32 s11, s11, 6291456
    v_mov_b32 v170, s10
    v_mov_b32 v171, 0
    v_mov_b32 v174, s10
    v_mov_b32 v175, 0
    v_mov_b32 v178, s10
    v_mov_b32 v179, 0
    v_mov_b32 v182, s10
    v_mov_b32 v183, 0
    v_mov_b32 v186, s10
    v_mov_b32 v187, 0
    v_mov_b32 v190, s10
    v_mov_b32 v191, 0
    v_mov_b32 v194, s10
    v_mov_b32 v195, 0
    v_mov_b32 v198, s10
    v_mov_b32 v199, 0
    v_mov_b32 v202, s10
    v_mov_b32 v203, 0
    v_mov_b32 v206, s10
    v_mov_b32 v207, 0
    s_waitcnt lgkmcnt(0)
    s_barrier
    ds_read_b128 v[16:19], v6 offset:0
    ds_read_b128 v[20:23], v6 offset:64
    ds_read_b128 v[24:27], v6 offset:128
    ds_read_b128 v[28:31], v6 offset:192
    s_waitcnt lgkmcnt(3)
    v_mfma_f32_16x16x32_bf16 v[112:115], v[32:35], v[16:19], 0
    v_mfma_f32_16x16x32_bf16 v[116:119], v[36:39], v[16:19], 0
    v_mfma_f32_16x16x32_bf16 v[120:123], v[40:43], v[16:19], 0
    v_mfma_f32_16x16x32_bf16 v[124:127], v[44:47], v[16:19], 0
    v_mfma_f32_16x16x32_bf16 v[128:131], v[48:51], v[16:19], 0
    s_waitcnt lgkmcnt(2)
    v_mfma_f32_16x16x32_bf16 v[112:115], v[52:55], v[20:23], v[112:115]
    v_mfma_f32_16x16x32_bf16 v[116:119], v[56:59], v[20:23], v[116:119]
    v_mfma_f32_16x16x32_bf16 v[120:123], v[60:63], v[20:23], v[120:123]
    v_mfma_f32_16x16x32_bf16 v[124:127], v[64:67], v[20:23], v[124:127]
    v_mfma_f32_16x16x32_bf16 v[128:131], v[68:71], v[20:23], v[128:131]
    s_waitcnt lgkmcnt(1)
    v_mfma_f32_16x16x32_bf16 v[112:115], v[72:75], v[24:27], v[112:115]
    v_mfma_f32_16x16x32_bf16 v[116:119], v[76:79], v[24:27], v[116:119]
    v_mfma_f32_16x16x32_bf16 v[120:123], v[80:83], v[24:27], v[120:123]
    v_mfma_f32_16x16x32_bf16 v[124:127], v[84:87], v[24:27], v[124:127]
    v_mfma_f32_16x16x32_bf16 v[128:131], v[88:91], v[24:27], v[128:131]
    s_waitcnt lgkmcnt(0)
    v_mfma_f32_16x16x32_bf16 v[112:115], v[92:95], v[28:31], v[112:115]
    v_mfma_f32_16x16x32_bf16 v[116:119], v[96:99], v[28:31], v[116:119]
    v_mfma_f32_16x16x32_bf16 v[120:123], v[100:103], v[28:31], v[120:123]
    v_mfma_f32_16x16x32_bf16 v[124:127], v[104:107], v[28:31], v[124:127]
    v_mfma_f32_16x16x32_bf16 v[128:131], v[108:111], v[28:31], v[128:131]
    v_cmp_gt_u32 vcc, 2, v1
    s_and_b64 exec, exec, vcc
    s_nop 1
    v_mov_b32 v168, v112
    v_mov_b32 v169, v113
    buffer_store_dwordx4 v[168:171], v7, s[52:55], s11 offen offset:0 sc1
    v_mov_b32 v172, v114
    v_mov_b32 v173, v115
    buffer_store_dwordx4 v[172:175], v7, s[52:55], s11 offen offset:128 sc1
    v_mov_b32 v176, v116
    v_mov_b32 v177, v117
    buffer_store_dwordx4 v[176:179], v7, s[52:55], s11 offen offset:256 sc1
    v_mov_b32 v180, v118
    v_mov_b32 v181, v119
    buffer_store_dwordx4 v[180:183], v7, s[52:55], s11 offen offset:384 sc1
    v_mov_b32 v184, v120
    v_mov_b32 v185, v121
    buffer_store_dwordx4 v[184:187], v7, s[52:55], s11 offen offset:512 sc1
    v_mov_b32 v188, v122
    v_mov_b32 v189, v123
    buffer_store_dwordx4 v[188:191], v7, s[52:55], s11 offen offset:640 sc1
    v_mov_b32 v192, v124
    v_mov_b32 v193, v125
    buffer_store_dwordx4 v[192:195], v7, s[52:55], s11 offen offset:768 sc1
    v_mov_b32 v196, v126
    v_mov_b32 v197, v127
    buffer_store_dwordx4 v[196:199], v7, s[52:55], s11 offen offset:896 sc1
    v_mov_b32 v200, v128
    v_mov_b32 v201, v129
    buffer_store_dwordx4 v[200:203], v7, s[52:55], s11 offen offset:1024 sc1
    v_mov_b32 v204, v130
    v_mov_b32 v205, v131
    buffer_store_dwordx4 v[204:207], v7, s[52:55], s11 offen offset:1152 sc1
    s_mov_b64 exec, -1
L_p2wo:
    s_cmp_lt_u32 s5, 4
    s_cbranch_scc1 L_p2w1
    buffer_load_dwordx2 v[160:161], v235, s[52:55], 0 offen sc1
    buffer_load_dwordx4 v[162:165], v233, s[40:43], 0 offen
    buffer_load_dwordx4 v[166:169], v233, s[40:43], 0 offen offset:64
    buffer_load_dwordx2 v[170:171], v234, s[40:43], 0 offen offset:128
L_p2w1:
    v_mov_b32 v8, 158848
    v_mov_b32 v3, 1
    s_waitcnt vmcnt(0)
    s_mov_b64 exec, 1
    ds_add_u32 v8, v3 offset:4
    s_mov_b64 exec, -1
    s_cmp_lt_u32 s5, 4
    s_cbranch_scc1 L_phase2
    s_mov_b32 s15, 200000
L_pc_13:
    v_cmp_ne_u32 vcc, s10, v161
    s_cmp_eq_u64 vcc, 0
    s_cbranch_scc1 L_pk_14
    s_sub_u32 s15, s15, 1
    s_cmp_eq_u32 s15, 0
    s_cbranch_scc1 L_pk_14
    s_sleep 8
    buffer_load_dwordx2 v[160:161], v235, s[52:55], 0 offen sc1
    s_waitcnt vmcnt(0)
    s_branch L_pc_13
L_pk_14:
    v_permlane16_swap_b32 v162, v164
    v_permlane16_swap_b32 v163, v165
    v_permlane16_swap_b32 v166, v168
    v_permlane16_swap_b32 v167, v169
    v_and_b32 v46, 0xffff0000, v160
    v_rcp_f32 v46, v46
    v_lshlrev_b32 v160, 16, v160
    v_lshlrev_b32 v16, 16, v162
    v_and_b32 v17, 0xffff0000, v162
    v_lshlrev_b32 v18, 16, v163
    v_and_b32 v19, 0xffff0000, v163
    v_lshlrev_b32 v20, 16, v164
    v_and_b32 v21, 0xffff0000, v164
    v_lshlrev_b32 v22, 16, v165
    v_and_b32 v23, 0xffff0000, v165
    v_lshlrev_b32 v24, 16, v166
    v_and_b32 v25, 0xffff0000, v166
    v_lshlrev_b32 v26, 16, v167
    v_and_b32 v27, 0xffff0000, v167
    v_lshlrev_b32 v28, 16, v168
    v_and_b32 v29, 0xffff0000, v168
    v_lshlrev_b32 v30, 16, v169
    v_and_b32 v31, 0xffff0000, v169
    v_lshlrev_b32 v32, 16, v170
    v_and_b32 v33, 0xffff0000, v170
    v_lshlrev_b32 v34, 16, v171
    v_and_b32 v35, 0xffff0000, v171
    v_pk_add_f32 v[176:177], v[16:17], v[160:161] op_sel_hi:[1,0] neg_lo:[0,1] neg_hi:[0,1]
    v_pk_add_f32 v[178:179], v[18:19], v[160:161] op_sel_hi:[1,0] neg_lo:[0,1] neg_hi:[0,1]
    v_pk_add_f32 v[180:181], v[20:21], v[160:161] op_sel_hi:[1,0] neg_lo:[0,1] neg_hi:[0,1]
    v_pk_add_f32 v[182:183], v[22:23], v[160:161] op_sel_hi:[1,0] neg_lo:[0,1] neg_hi:[0,1]
    v_pk_add_f32 v[184:185], v[24:25], v[160:161] op_sel_hi:[1,0] neg_lo:[0,1] neg_hi:[0,1]
    v_pk_add_f32 v[186:187], v[26:27], v[160:161] op_sel_hi:[1,0] neg_lo:[0,1] neg_hi:[0,1]
    v_pk_add_f32 v[188:189], v[28:29], v[160:161] op_sel_hi:[1,0] neg_lo:[0,1] neg_hi:[0,1]
    v_pk_add_f32 v[190:191], v[30:31], v[160:161] op_sel_hi:[1,0] neg_lo:[0,1] neg_hi:[0,1]
    v_pk_add_f32 v[192:193], v[32:33], v[160:161] op_sel_hi:[1,0] neg_lo:[0,1] neg_hi:[0,1]
    v_pk_add_f32 v[194:195], v[34:35], v[160:161] op_sel_hi:[1,0] neg_lo:[0,1] neg_hi:[0,1]
    v_cvt_pk_bf16_f32 v36, v176, v177
    v_cvt_pk_bf16_f32 v37, v178, v179
    v_cvt_pk_bf16_f32 v38, v180, v181
    v_cvt_pk_bf16_f32 v39, v182, v183
    v_cvt_pk_bf16_f32 v40, v184, v185
    v_cvt_pk_bf16_f32 v41, v186, v187
    v_cvt_pk_bf16_f32 v42, v188, v189
    v_cvt_pk_bf16_f32 v43, v190, v191
    v_cvt_pk_bf16_f32 v44, v192, v193
    v_cvt_pk_bf16_f32 v45, v194, v195
    v_lshlrev_b32 v176, 16, v36
    v_and_b32 v177, 0xffff0000, v36
    v_lshlrev_b32 v178, 16, v37
    v_and_b32 v179, 0xffff0000, v37
    v_lshlrev_b32 v180, 16, v38
    v_and_b32 v181, 0xffff0000, v38
    v_lshlrev_b32 v182, 16, v39
    v_and_b32 v183, 0xffff0000, v39
    v_lshlrev_b32 v184, 16, v40
    v_and_b32 v185, 0xffff0000, v40
    v_lshlrev_b32 v186, 16, v41
    v_and_b32 v187, 0xffff0000, v41
    v_lshlrev_b32 v188, 16, v42
    v_and_b32 v189, 0xffff0000, v42
    v_lshlrev_b32 v190, 16, v43
    v_and_b32 v191, 0xffff0000, v43
    v_lshlrev_b32 v192, 16, v44
    v_and_b32 v193, 0xffff0000, v44
    v_lshlrev_b32 v194, 16, v45
    v_and_b32 v195, 0xffff0000, v45
    v_pk_mul_f32 v[176:177], v[176:177], v[46:47] op_sel_hi:[1,0]
    v_pk_mul_f32 v[178:179], v[178:179], v[46:47] op_sel_hi:[1,0]
    v_pk_mul_f32 v[180:181], v[180:181], v[46:47] op_sel_hi:[1,0]
    v_pk_mul_f32 v[182:183], v[182:183], v[46:47] op_sel_hi:[1,0]
    v_pk_mul_f32 v[184:185], v[184:185], v[46:47] op_sel_hi:[1,0]
    v_pk_mul_f32 v[186:187], v[186:187], v[46:47] op_sel_hi:[1,0]
    v_pk_mul_f32 v[188:189], v[188:189], v[46:47] op_sel_hi:[1,0]
    v_pk_mul_f32 v[190:191], v[190:191], v[46:47] op_sel_hi:[1,0]
    v_pk_mul_f32 v[192:193], v[192:193], v[46:47] op_sel_hi:[1,0]
    v_pk_mul_f32 v[194:195], v[194:195], v[46:47] op_sel_hi:[1,0]
    v_cvt_pk_bf16_f32 v36, v176, v177
    v_cvt_pk_bf16_f32 v37, v178, v179
    v_cvt_pk_bf16_f32 v38, v180, v181
    v_cvt_pk_bf16_f32 v39, v182, v183
    v_cvt_pk_bf16_f32 v40, v184, v185
    v_cvt_pk_bf16_f32 v41, v186, v187
    v_cvt_pk_bf16_f32 v42, v188, v189
    v_cvt_pk_bf16_f32 v43, v190, v191
    v_cvt_pk_bf16_f32 v44, v192, v193
    v_cvt_pk_bf16_f32 v45, v194, v195
    v_lshlrev_b32 v176, 16, v36
    v_and_b32 v177, 0xffff0000, v36
    v_lshlrev_b32 v178, 16, v37
    v_and_b32 v179, 0xffff0000, v37
    v_lshlrev_b32 v180, 16, v38
    v_and_b32 v181, 0xffff0000, v38
    v_lshlrev_b32 v182, 16, v39
    v_and_b32 v183, 0xffff0000, v39
    v_lshlrev_b32 v184, 16, v40
    v_and_b32 v185, 0xffff0000, v40
    v_lshlrev_b32 v186, 16, v41
    v_and_b32 v187, 0xffff0000, v41
    v_lshlrev_b32 v188, 16, v42
    v_and_b32 v189, 0xffff0000, v42
    v_lshlrev_b32 v190, 16, v43
    v_and_b32 v191, 0xffff0000, v43
    v_lshlrev_b32 v192, 16, v44
    v_and_b32 v193, 0xffff0000, v44
    v_lshlrev_b32 v194, 16, v45
    v_and_b32 v195, 0xffff0000, v45
    v_pk_add_f32 v[176:177], v[176:177], v[16:17]
    v_pk_add_f32 v[178:179], v[178:179], v[18:19]
    v_pk_add_f32 v[180:181], v[180:181], v[20:21]
    v_pk_add_f32 v[182:183], v[182:183], v[22:23]
    v_pk_add_f32 v[184:185], v[184:185], v[24:25]
    v_pk_add_f32 v[186:187], v[186:187], v[26:27]
    v_pk_add_f32 v[188:189], v[188:189], v[28:29]
    v_pk_add_f32 v[190:191], v[190:191], v[30:31]
    v_pk_add_f32 v[192:193], v[192:193], v[32:33]
    v_pk_add_f32 v[194:195], v[194:195], v[34:35]
    s_lshl_b32 s11, s2, 3
    s_add_u32 s11, s11, s5
    s_cmpk_lg_u32 s11, 1927
    s_cbranch_scc1 L_noep
    v_add_u32 v4, 0x2e0000, v254
    s_mov_b32 s15, 200000
L_ep:
    buffer_load_dwordx4 v[16:19], v4, s[52:55], 0 offen sc1
    s_waitcnt vmcnt(0)
    v_xor_b32 v16, s10, v16
    v_xor_b32 v17, s10, v17
    v_xor_b32 v18, s10, v18
    v_xor_b32 v19, s10, v19
    v_or3_b32 v16, v16, v17, v18
    v_or_b32 v16, v16, v19
    v_lshlrev_b32 v16, 4, v16
    v_cmp_ne_u32 vcc, 0, v16
    s_cmp_eq_u64 vcc, 0
    s_cbranch_scc1 L_ep2
    s_sleep 8
    s_sub_u32 s15, s15, 1
    s_cmp_lg_u32 s15, 0
    s_cbranch_scc1 L_ep
L_ep2:
    v_mov_b32 v4, 0
    v_mov_b32 v5, s10
    s_mov_b64 exec, 1
    global_store_dword v4, v5, s[36:37] sc1
    s_mov_b64 exec, -1
L_noep:
    s_cmp_lg_u32 s5, 6
    s_cbranch_scc1 L_phase2
    v_mov_b32 v4, 0
    s_mov_b32 s15, 200000
L_sel:
    buffer_load_dwordx4 v[16:19], v4, s[52:55], 0 offen offset:256 sc1
    s_waitcnt vmcnt(0)
    v_readfirstlane_b32 s11, v17
    v_readfirstlane_b32 s12, v19
    v_readfirstlane_b32 s76, v16
    v_readfirstlane_b32 s79, v18
    s_cmp_eq_u32 s11, s12
    s_cselect_b32 s11, s11, 0
    s_cselect_b32 s12, s10, 1
    s_mov_b32 s78, 0
    s_cmp_eq_u32 s11, s12
    s_cbranch_scc1 L_phase2
    s_sleep 8
    s_sub_u32 s15, s15, 1
    s_cmp_lg_u32 s15, 0
    s_cbranch_scc1 L_sel
    s_branch L_phase2
L_selok:
    s_and_b32 s77, s76, 0xffff
    s_sub_u32 s77, 2047, s77
    s_lshl_b32 s11, s78, 2
    s_add_u32 s11, s11, 158976
    v_mov_b32 v3, s11
    v_mov_b32 v4, s77
    ds_write_b32 v3, v4
    s_lshr_b32 s11, s77, 6
    s_lshr_b32 s12, s60, 2
    s_cmp_lg_u32 s11, s12
    s_cbranch_scc1 L_selnext
    v_mul_u32_u24 v3, 13, v0
    v_lshrrev_b32 v3, 8, v3
    v_mul_u32_u24 v4, 20, v3
    v_sub_u32 v4, v0, v4
    v_mul_u32_u24 v5, 40960, v3
    v_lshl_add_u32 v5, v4, 5, v5
    v_lshrrev_b32 v4, 2, v4
    v_lshl_add_u32 v5, v4, 7, v5
    s_lshr_b32 s14, s4, 2
    s_mul_i32 s14, s14, 1280
    s_lshl_b32 s13, s78, 4
    s_add_u32 s14, s14, s13
    s_add_u32 s14, s14, 6291456
    s_lshr_b32 s11, s76, 16
    s_bitcmp1_b32 s11, 15
    s_mov_b32 s13, 0xffff
    s_cmov_b32 s13, 0x8000
    s_xor_b32 s11, s11, s13
    s_lshl_b32 s11, s11, 16
    v_mov_b32 v6, 0xbfb8aa3b
    v_mul_f32 v6, s11, v6
    v_exp_f32 v6, v6
    s_nop 0
    v_add_f32 v6, 1.0, v6
    v_rcp_f32 v6, v6
    s_nop 0
    v_cvt_pk_bf16_f32 v6, v6, v6
    v_and_b32 v6, 0xffff0000, v6
    s_mul_i32 s11, s78, 1536
    s_add_u32 s11, s11, 158992
    v_add_u32 v7, s11, v254
    s_mov_b32 s15, 200000
    s_mov_b32 exec_hi, 0xfffffff
L_yf:
    s_mov_b32 s12, s14
    buffer_load_dwordx3 v[196:198], v5, s[52:55], s12 offen offset:0 sc1
    buffer_load_dwordx3 v[200:202], v5, s[52:55], s12 offen offset:128 sc1
    s_add_u32 s12, s12, 10240
    buffer_load_dwordx3 v[204:206], v5, s[52:55], s12 offen offset:0 sc1
    buffer_load_dwordx3 v[208:210], v5, s[52:55], s12 offen offset:128 sc1
    s_add_u32 s12, s12, 10240
    buffer_load_dwordx3 v[212:214], v5, s[52:55], s12 offen offset:0 sc1
    buffer_load_dwordx3 v[216:218], v5, s[52:55], s12 offen offset:128 sc1
    s_add_u32 s12, s12, 10240
    buffer_load_dwordx3 v[220:222], v5, s[52:55], s12 offen offset:0 sc1
    buffer_load_dwordx3 v[224:226], v5, s[52:55], s12 offen offset:128 sc1
    s_waitcnt vmcnt(0)
    v_mov_b32 v3, 0
    v_xor_b32 v4, s10, v198
    v_xor_b32 v10, s10, v202
    v_or3_b32 v3, v3, v4, v10
    v_xor_b32 v4, s10, v206
    v_xor_b32 v10, s10, v210
    v_or3_b32 v3, v3, v4, v10
    v_xor_b32 v4, s10, v214
    v_xor_b32 v10, s10, v218
    v_or3_b32 v3, v3, v4, v10
    v_xor_b32 v4, s10, v222
    v_xor_b32 v10, s10, v226
    v_or3_b32 v3, v3, v4, v10
    v_cmp_ne_u32 vcc, 0, v3
    s_cmp_eq_u64 vcc, 0
    s_cbranch_scc1 L_yok
    s_mov_b64 exec, vcc
    s_sleep 4
    s_sub_u32 s15, s15, 1
    s_cmp_lg_u32 s15, 0
    s_cbranch_scc1 L_yf
L_yok:
    s_mov_b32 exec_lo, -1
    s_mov_b32 exec_hi, 0xfffffff
    v_pk_add_f32 v[236:237], v[196:197], v[204:205]
    v_pk_add_f32 v[238:239], v[200:201], v[208:209]
    v_pk_add_f32 v[236:237], v[236:237], v[212:213]
    v_pk_add_f32 v[238:239], v[238:239], v[216:217]
    v_pk_add_f32 v[236:237], v[236:237], v[220:221]
    v_pk_add_f32 v[238:239], v[238:239], v[224:225]
    ds_write_b128 v7, v[236:239] offset:320
    s_mov_b64 exec, 0xfffff
    ds_read_b128 v[240:243], v7 offset:640
    ds_read_b128 v[228:231], v7 offset:960
    s_waitcnt lgkmcnt(0)
    v_pk_add_f32 v[236:237], v[236:237], v[240:241]
    v_pk_add_f32 v[238:239], v[238:239], v[242:243]
    v_pk_add_f32 v[236:237], v[236:237], v[228:229]
    v_pk_add_f32 v[238:239], v[238:239], v[230:231]
    v_cvt_pk_bf16_f32 v240, v236, v237
    v_cvt_pk_bf16_f32 v241, v238, v239
    v_lshlrev_b32 v236, 16, v240
    v_and_b32 v237, 0xffff0000, v240
    v_lshlrev_b32 v238, 16, v241
    v_and_b32 v239, 0xffff0000, v241
    v_mul_f32 v236, v236, v6
    v_mul_f32 v237, v237, v6
    v_mul_f32 v238, v238, v6
    v_mul_f32 v239, v239, v6
    v_cvt_pk_bf16_f32 v240, v236, v237
    v_cvt_pk_bf16_f32 v241, v238, v239
    v_lshlrev_b32 v236, 16, v240
    v_and_b32 v237, 0xffff0000, v240
    v_lshlrev_b32 v238, 16, v241
    v_and_b32 v239, 0xffff0000, v241
    ds_write_b128 v7, v[236:239]
    s_waitcnt lgkmcnt(0)
    s_mov_b64 exec, -1
L_selnext:
    s_mov_b32 s76, s79
    s_add_u32 s78, s78, 1
    s_cmp_lt_u32 s78, 2
    s_cbranch_scc1 L_selok
    v_mov_b32 v3, 0x1000000
    s_mov_b64 exec, 1
    ds_add_u32 v8, v3 offset:4
    s_mov_b64 exec, -1
    s_branch L_yret
L_w23:
    s_waitcnt lgkmcnt(0)
    s_load_dword s10, s[36:37], 0
    s_mov_b32 s40, s16
    s_mov_b32 s41, s17
    s_mov_b32 s42, 2621440
    s_mov_b32 s43, 0x20000
    s_mov_b32 s52, s36
    s_mov_b32 s53, s37
    s_mov_b32 s54, 11534336
    s_mov_b32 s55, 0x20000
    v_and_b32 v100, 15, v0
    v_lshrrev_b32 v101, 4, v0
    s_lshl_b32 s11, s5, 4
    v_add_u32 v102, s11, v100
    v_mul_u32_u24 v102, 496, v102
    v_lshlrev_b32 v103, 3, v101
    v_mov_b32 v104, 0x08100800
    v_lshrrev_b32 v103, v103, v104
    v_and_b32 v103, 0xff, v103
    v_add_u32 v231, v102, v103
    v_add_u32 v228, 7936, v231
    v_lshrrev_b32 v102, 2, v0
    v_add_u32 v102, s11, v102
    v_mul_u32_u24 v102, 496, v102
    v_and_b32 v103, 3, v0
    v_lshl_add_u32 v229, v103, 3, v102
    v_and_b32 v102, 1, v0
    v_lshl_add_u32 v103, v101, 2, v102
    v_lshlrev_b32 v102, 4, v102
    v_mov_b32 v104, 0xffff
    v_lshlrev_b32 v104, v102, v104
    v_cmp_le_u32 vcc, v103, v100
    s_nop 1
    v_cndmask_b32 v212, 0, v104, vcc
    v_xor_b32 v214, v212, v104
    v_add_u32 v103, 2, v103
    v_cmp_le_u32 vcc, v103, v100
    s_nop 1
    v_cndmask_b32 v213, 0, v104, vcc
    v_xor_b32 v215, v213, v104
    v_mov_b32 v196, 0
    v_mov_b32 v197, 0
    v_mov_b32 v198, 0
    v_mov_b32 v199, 0
    v_mov_b32 v200, 0
    v_mov_b32 v201, 0
    v_mov_b32 v202, 0
    v_mov_b32 v203, 0
    v_mov_b32 v204, 0
    v_mov_b32 v205, 0
    v_mov_b32 v206, 0
    v_mov_b32 v207, 0
    v_mov_b32 v208, 0
    v_mov_b32 v209, 0
    v_mov_b32 v210, 0
    v_mov_b32 v211, 0
    s_lshl_b32 s60, s3, 2
    s_and_b32 s11, s4, 3
    s_add_u32 s60, s60, s11
    s_lshl_b32 s60, s60, 2
    s_and_b32 s12, s5, 3
    s_add_u32 s60, s60, s12
    s_lshr_b32 s61, s5, 2
    s_xor_b32 s61, s61, s3
    s_and_b32 s61, s61, 1
    s_lshr_b32 s62, s4, 2
    s_mul_i32 s62, s62, 80
    s_mov_b32 s38, 0
    v_and_b32 v100, 15, v0
    v_lshrrev_b32 v101, 4, v0
    s_lshl_b32 s12, s60, 4
    v_add_u32 v102, s12, v100
    v_lshlrev_b32 v235, 3, v102
    v_add_u32 v235, 4096, v235
    v_mul_u32_u24 v102, 1280, v102
    v_lshl_add_u32 v102, v101, 3, v102
    s_lshl_b32 s12, s62, 1
    v_add_u32 v234, s12, v102
    v_lshlrev_b32 v254, 4, v0
    v_and_b32 v102, 1, v101
    v_mul_u32_u24 v102, 24, v102
    v_add_u32 v233, v234, v102
    v_lshrrev_b32 v102, 2, v0
    v_and_b32 v103, 3, v0
    v_mul_u32_u24 v102, 160, v102
    v_lshl_add_u32 v102, v103, 3, v102
    s_xor_b32 s12, s61, s11
    s_and_b32 s12, s12, 1
    s_mul_i32 s12, s12, 51200
    s_add_u32 s12, s12, 55552
    v_add_u32 v244, s12, v102
    v_add_u32 v103, 10240, v244
    v_cmp_gt_u32 vcc, 16, v0
    s_nop 1
    v_cndmask_b32 v245, v244, v103, vcc
    v_cmp_gt_u32 vcc, 32, v0
    s_nop 1
    v_cndmask_b32 v246, v244, v103, vcc
    v_cmp_gt_u32 vcc, 48, v0
    s_nop 1
    v_cndmask_b32 v247, v244, v103, vcc
    s_mov_b32 s56, s32
    s_mov_b32 s57, s33
    s_mov_b32 s58, 2621440
    s_mov_b32 s59, 0x20000
    s_mul_i32 s12, s60, 10
    s_mul_i32 s11, s61, 5
    s_add_u32 s12, s12, s11
    s_lshl_b32 s63, s12, 7
    s_add_u32 s63, s63, 2818048
    s_and_b32 s11, s5, 3
    s_mul_i32 s11, s11, 9920
    s_add_u32 s11, s11, 160
    v_mul_u32_u24 v101, 240, v101
    v_add3_u32 v232, v101, v254, s11
    s_lshl_b32 s22, s12, 11
    s_add_u32 s22, s22, 3145728
    s_add_u32 s23, s22, 4096
    s_add_u32 s24, s22, 8192
    s_cmp_ge_u32 s60, 36
    s_cselect_b32 s11, 1, 0
    s_cmpk_ge_u32 s60, 66
    s_addc_u32 s11, s11, 0
    s_cmpk_ge_u32 s60, 102
    s_addc_u32 s11, s11, 0
    s_lshl_b32 s11, s11, 1
    s_add_u32 s11, s11, s61
    s_cmp_eq_u32 s11, s3
    s_cselect_b32 s100, 1, 0
    s_waitcnt lgkmcnt(0)
    s_add_u32 s10, s10, 1
    s_branch L_gemm
L_stats2:
    s_load_dword s10, s[36:37], 0
    s_mov_b32 s52, s36
    s_mov_b32 s53, s37
    s_mov_b32 s54, 11534336
    s_mov_b32 s55, 0x20000
    v_and_b32 v100, 15, v0
    v_lshrrev_b32 v101, 4, v0
    s_lshl_b32 s11, s5, 4
    v_add_u32 v102, s11, v100
    v_mul_u32_u24 v102, 496, v102
    v_lshlrev_b32 v103, 3, v101
    v_mov_b32 v104, 0x08100800
    v_lshrrev_b32 v103, v103, v104
    v_and_b32 v103, 0xff, v103
    v_add_u32 v231, v102, v103
    v_add_u32 v228, 7936, v231
    v_lshrrev_b32 v102, 2, v0
    v_add_u32 v102, s11, v102
    v_mul_u32_u24 v102, 496, v102
    v_and_b32 v103, 3, v0
    v_lshl_add_u32 v229, v103, 3, v102
    v_and_b32 v102, 1, v0
    v_lshl_add_u32 v103, v101, 2, v102
    v_lshlrev_b32 v102, 4, v102
    v_mov_b32 v104, 0xffff
    v_lshlrev_b32 v104, v102, v104
    v_cmp_le_u32 vcc, v103, v100
    s_nop 1
    v_cndmask_b32 v212, 0, v104, vcc
    v_xor_b32 v214, v212, v104
    v_add_u32 v103, 2, v103
    v_cmp_le_u32 vcc, v103, v100
    s_nop 1
    v_cndmask_b32 v213, 0, v104, vcc
    v_xor_b32 v215, v213, v104
    v_mov_b32 v196, 0
    v_mov_b32 v197, 0
    v_mov_b32 v198, 0
    v_mov_b32 v199, 0
    v_mov_b32 v200, 0
    v_mov_b32 v201, 0
    v_mov_b32 v202, 0
    v_mov_b32 v203, 0
    v_mov_b32 v204, 0
    v_mov_b32 v205, 0
    v_mov_b32 v206, 0
    v_mov_b32 v207, 0
    v_mov_b32 v208, 0
    v_mov_b32 v209, 0
    v_mov_b32 v210, 0
    v_mov_b32 v211, 0
    s_lshl_b32 s60, s3, 2
    s_and_b32 s11, s4, 3
    s_add_u32 s60, s60, s11
    s_lshl_b32 s60, s60, 2
    s_and_b32 s12, s5, 3
    s_add_u32 s60, s60, s12
    s_lshr_b32 s61, s5, 2
    s_xor_b32 s61, s61, s3
    s_and_b32 s61, s61, 1
    s_lshr_b32 s62, s4, 2
    s_mul_i32 s62, s62, 80
    s_mov_b32 s38, 0
    v_and_b32 v100, 15, v0
    v_lshrrev_b32 v101, 4, v0
    s_lshl_b32 s12, s60, 4
    v_add_u32 v102, s12, v100
    v_lshlrev_b32 v235, 3, v102
    v_add_u32 v235, 4096, v235
    v_mul_u32_u24 v102, 1280, v102
    v_lshl_add_u32 v102, v101, 3, v102
    s_lshl_b32 s12, s62, 1
    v_add_u32 v234, s12, v102
    v_lshlrev_b32 v254, 4, v0
    v_and_b32 v102, 1, v101
    v_mul_u32_u24 v102, 24, v102
    v_add_u32 v233, v234, v102
    v_lshrrev_b32 v102, 2, v0
    v_and_b32 v103, 3, v0
    v_mul_u32_u24 v102, 160, v102
    v_lshl_add_u32 v102, v103, 3, v102
    s_xor_b32 s12, s61, s11
    s_and_b32 s12, s12, 1
    s_mul_i32 s12, s12, 51200
    s_add_u32 s12, s12, 55552
    v_add_u32 v244, s12, v102
    v_add_u32 v103, 10240, v244
    v_cmp_gt_u32 vcc, 16, v0
    s_nop 1
    v_cndmask_b32 v245, v244, v103, vcc
    v_cmp_gt_u32 vcc, 32, v0
    s_nop 1
    v_cndmask_b32 v246, v244, v103, vcc
    v_cmp_gt_u32 vcc, 48, v0
    s_nop 1
    v_cndmask_b32 v247, v244, v103, vcc
    s_mov_b32 s56, s32
    s_mov_b32 s57, s33
    s_mov_b32 s58, 2621440
    s_mov_b32 s59, 0x20000
    s_mul_i32 s12, s60, 10
    s_mul_i32 s11, s61, 5
    s_add_u32 s12, s12, s11
    s_lshl_b32 s63, s12, 7
    s_add_u32 s63, s63, 2818048
    s_and_b32 s11, s5, 3
    s_mul_i32 s11, s11, 9920
    s_add_u32 s11, s11, 160
    v_mul_u32_u24 v101, 240, v101
    v_add3_u32 v232, v101, v254, s11
    s_lshl_b32 s22, s12, 11
    s_add_u32 s22, s22, 3145728
    s_add_u32 s23, s22, 4096
    s_add_u32 s24, s22, 8192
    s_cmp_ge_u32 s60, 36
    s_cselect_b32 s11, 1, 0
    s_cmpk_ge_u32 s60, 66
    s_addc_u32 s11, s11, 0
    s_cmpk_ge_u32 s60, 102
    s_addc_u32 s11, s11, 0
    s_lshl_b32 s11, s11, 1
    s_add_u32 s11, s11, s61
    s_cmp_eq_u32 s11, s3
    s_cselect_b32 s100, 1, 0
    v_mov_b32 v9, 0x3f803f80
    v_mov_b32 v10, 0
    v_mov_b32 v11, 0
    v_mov_b32 v12, 0
    v_mov_b32 v13, 0
    s_waitcnt vmcnt(0)
    v_dot2c_f32_bf16 v10, v20, v9
    v_dot2c_f32_bf16 v11, v21, v9
    v_dot2c_f32_bf16 v12, v22, v9
    v_dot2c_f32_bf16 v13, v23, v9
    v_dot2c_f32_bf16 v10, v24, v9
    v_dot2c_f32_bf16 v11, v25, v9
    v_dot2c_f32_bf16 v12, v26, v9
    v_dot2c_f32_bf16 v13, v27, v9
    v_dot2c_f32_bf16 v10, v28, v9
    v_dot2c_f32_bf16 v11, v29, v9
    v_dot2c_f32_bf16 v12, v30, v9
    v_dot2c_f32_bf16 v13, v31, v9
    v_dot2c_f32_bf16 v10, v32, v9
    v_dot2c_f32_bf16 v11, v33, v9
    v_dot2c_f32_bf16 v12, v34, v9
    v_dot2c_f32_bf16 v13, v35, v9
    v_dot2c_f32_bf16 v10, v36, v9
    v_dot2c_f32_bf16 v11, v37, v9
    v_dot2c_f32_bf16 v12, v38, v9
    v_dot2c_f32_bf16 v13, v39, v9
    v_lshlrev_b32 v60, 16, v20
    v_and_b32 v61, 0xffff0000, v20
    v_lshlrev_b32 v62, 16, v21
    v_and_b32 v63, 0xffff0000, v21
    v_lshlrev_b32 v64, 16, v22
    v_and_b32 v65, 0xffff0000, v22
    v_lshlrev_b32 v66, 16, v23
    v_and_b32 v67, 0xffff0000, v23
    v_lshlrev_b32 v68, 16, v24
    v_and_b32 v69, 0xffff0000, v24
    v_lshlrev_b32 v70, 16, v25
    v_and_b32 v71, 0xffff0000, v25
    v_lshlrev_b32 v72, 16, v26
    v_and_b32 v73, 0xffff0000, v26
    v_lshlrev_b32 v74, 16, v27
    v_and_b32 v75, 0xffff0000, v27
    v_lshlrev_b32 v76, 16, v28
    v_and_b32 v77, 0xffff0000, v28
    v_lshlrev_b32 v78, 16, v29
    v_and_b32 v79, 0xffff0000, v29
    v_add_f32 v10, v10, v11
    v_add_f32 v12, v12, v13
    v_add_f32 v6, v10, v12
    v_lshlrev_b32 v80, 16, v30
    v_and_b32 v81, 0xffff0000, v30
    v_lshlrev_b32 v82, 16, v31
    v_and_b32 v83, 0xffff0000, v31
    v_add_f32_dpp v6, v6, v6 row_ror:8 row_mask:0xf bank_mask:0xf
    v_lshlrev_b32 v84, 16, v32
    v_and_b32 v85, 0xffff0000, v32
    v_lshlrev_b32 v86, 16, v33
    v_and_b32 v87, 0xffff0000, v33
    v_add_f32_dpp v6, v6, v6 row_ror:4 row_mask:0xf bank_mask:0xf
    v_lshlrev_b32 v88, 16, v34
    v_and_b32 v89, 0xffff0000, v34
    v_lshlrev_b32 v90, 16, v35
    v_and_b32 v91, 0xffff0000, v35
    v_add_f32_dpp v6, v6, v6 row_ror:2 row_mask:0xf bank_mask:0xf
    v_lshlrev_b32 v92, 16, v36
    v_and_b32 v93, 0xffff0000, v36
    v_lshlrev_b32 v94, 16, v37
    v_and_b32 v95, 0xffff0000, v37
    v_add_f32_dpp v6, v6, v6 row_ror:1 row_mask:0xf bank_mask:0xf
    v_lshlrev_b32 v96, 16, v38
    v_and_b32 v97, 0xffff0000, v38
    v_lshlrev_b32 v98, 16, v39
    v_and_b32 v99, 0xffff0000, v39
    v_mul_f32 v7, 0x3acccccd, v6
    v_cvt_pk_bf16_f32 v8, v7, v7
    v_lshlrev_b32 v6, 16, v8
    v_mov_b32 v10, 0
    v_mov_b32 v11, 0
    v_mov_b32 v12, 0
    v_mov_b32 v13, 0
    v_sub_f32 v60, v60, v6
    v_sub_f32 v61, v61, v6
    v_sub_f32 v62, v62, v6
    v_sub_f32 v63, v63, v6
    v_sub_f32 v64, v64, v6
    v_sub_f32 v65, v65, v6
    v_sub_f32 v66, v66, v6
    v_sub_f32 v67, v67, v6
    v_sub_f32 v68, v68, v6
    v_sub_f32 v69, v69, v6
    v_sub_f32 v70, v70, v6
    v_sub_f32 v71, v71, v6
    v_sub_f32 v72, v72, v6
    v_sub_f32 v73, v73, v6
    v_sub_f32 v74, v74, v6
    v_sub_f32 v75, v75, v6
    v_sub_f32 v76, v76, v6
    v_sub_f32 v77, v77, v6
    v_sub_f32 v78, v78, v6
    v_sub_f32 v79, v79, v6
    v_sub_f32 v80, v80, v6
    v_sub_f32 v81, v81, v6
    v_sub_f32 v82, v82, v6
    v_sub_f32 v83, v83, v6
    v_sub_f32 v84, v84, v6
    v_sub_f32 v85, v85, v6
    v_sub_f32 v86, v86, v6
    v_sub_f32 v87, v87, v6
    v_sub_f32 v88, v88, v6
    v_sub_f32 v89, v89, v6
    v_sub_f32 v90, v90, v6
    v_sub_f32 v91, v91, v6
    v_sub_f32 v92, v92, v6
    v_sub_f32 v93, v93, v6
    v_sub_f32 v94, v94, v6
    v_sub_f32 v95, v95, v6
    v_sub_f32 v96, v96, v6
    v_sub_f32 v97, v97, v6
    v_sub_f32 v98, v98, v6
    v_sub_f32 v99, v99, v6
    v_fmac_f32 v10, v60, v60
    v_fmac_f32 v11, v61, v61
    v_fmac_f32 v12, v62, v62
    v_fmac_f32 v13, v63, v63
    v_fmac_f32 v10, v64, v64
    v_fmac_f32 v11, v65, v65
    v_fmac_f32 v12, v66, v66
    v_fmac_f32 v13, v67, v67
    v_fmac_f32 v10, v68, v68
    v_fmac_f32 v11, v69, v69
    v_fmac_f32 v12, v70, v70
    v_fmac_f32 v13, v71, v71
    v_fmac_f32 v10, v72, v72
    v_fmac_f32 v11, v73, v73
    v_fmac_f32 v12, v74, v74
    v_fmac_f32 v13, v75, v75
    v_fmac_f32 v10, v76, v76
    v_fmac_f32 v11, v77, v77
    v_fmac_f32 v12, v78, v78
    v_fmac_f32 v13, v79, v79
    v_fmac_f32 v10, v80, v80
    v_fmac_f32 v11, v81, v81
    v_fmac_f32 v12, v82, v82
    v_fmac_f32 v13, v83, v83
    v_fmac_f32 v10, v84, v84
    v_fmac_f32 v11, v85, v85
    v_fmac_f32 v12, v86, v86
    v_fmac_f32 v13, v87, v87
    v_fmac_f32 v10, v88, v88
    v_fmac_f32 v11, v89, v89
    v_fmac_f32 v12, v90, v90
    v_fmac_f32 v13, v91, v91
    v_fmac_f32 v10, v92, v92
    v_fmac_f32 v11, v93, v93
    v_fmac_f32 v12, v94, v94
    v_fmac_f32 v13, v95, v95
    v_fmac_f32 v10, v96, v96
    v_fmac_f32 v11, v97, v97
    v_fmac_f32 v12, v98, v98
    v_fmac_f32 v13, v99, v99
    v_sub_f32 v7, v7, v6
    v_add_f32 v10, v10, v11
    v_add_f32 v12, v12, v13
    v_add_f32 v14, v10, v12
    v_mov_b32 v10, 0
    v_mov_b32 v11, 0
    v_cvt_pk_bf16_f32 v20, v60, v61
    v_cvt_pk_bf16_f32 v21, v62, v63
    v_cvt_pk_bf16_f32 v22, v64, v65
    v_cvt_pk_bf16_f32 v23, v66, v67
    v_cvt_pk_bf16_f32 v24, v68, v69
    v_add_f32_dpp v14, v14, v14 row_ror:8 row_mask:0xf bank_mask:0xf
    v_cvt_pk_bf16_f32 v25, v70, v71
    v_cvt_pk_bf16_f32 v26, v72, v73
    v_cvt_pk_bf16_f32 v27, v74, v75
    v_cvt_pk_bf16_f32 v28, v76, v77
    v_cvt_pk_bf16_f32 v29, v78, v79
    v_add_f32_dpp v14, v14, v14 row_ror:4 row_mask:0xf bank_mask:0xf
    v_cvt_pk_bf16_f32 v30, v80, v81
    v_cvt_pk_bf16_f32 v31, v82, v83
    v_cvt_pk_bf16_f32 v32, v84, v85
    v_cvt_pk_bf16_f32 v33, v86, v87
    v_cvt_pk_bf16_f32 v34, v88, v89
    v_add_f32_dpp v14, v14, v14 row_ror:2 row_mask:0xf bank_mask:0xf
    v_cvt_pk_bf16_f32 v35, v90, v91
    v_cvt_pk_bf16_f32 v36, v92, v93
    v_cvt_pk_bf16_f32 v37, v94, v95
    v_cvt_pk_bf16_f32 v38, v96, v97
    v_cvt_pk_bf16_f32 v39, v98, v99
    v_add_f32_dpp v14, v14, v14 row_ror:1 row_mask:0xf bank_mask:0xf
    s_waitcnt vmcnt(0)
    v_dot2c_f32_bf16 v10, v20, v40
    v_dot2c_f32_bf16 v11, v21, v41
    v_dot2c_f32_bf16 v10, v22, v42
    v_dot2c_f32_bf16 v11, v23, v43
    v_dot2c_f32_bf16 v10, v24, v44
    v_dot2c_f32_bf16 v11, v25, v45
    v_dot2c_f32_bf16 v10, v26, v46
    v_dot2c_f32_bf16 v11, v27, v47
    v_dot2c_f32_bf16 v10, v28, v48
    v_dot2c_f32_bf16 v11, v29, v49
    v_dot2c_f32_bf16 v10, v30, v50
    v_dot2c_f32_bf16 v11, v31, v51
    v_dot2c_f32_bf16 v10, v32, v52
    v_dot2c_f32_bf16 v11, v33, v53
    v_dot2c_f32_bf16 v10, v34, v54
    v_dot2c_f32_bf16 v11, v35, v55
    v_dot2c_f32_bf16 v10, v36, v56
    v_dot2c_f32_bf16 v11, v37, v57
    v_dot2c_f32_bf16 v10, v38, v58
    v_dot2c_f32_bf16 v11, v39, v59
    v_mul_f32 v14, 0x3acccccd, v14
    v_fma_f32 v14, -v7, v7, v14
    v_max_f32 v14, 0, v14
    v_cvt_pk_bf16_f32 v14, v14, v14
    v_add_f32 v10, v10, v11
    v_and_b32 v14, 0xffff0000, v14
    v_add_f32 v14, 0x3727c5ac, v14
    v_add_f32_dpp v10, v10, v10 row_ror:8 row_mask:0xf bank_mask:0xf
    v_cvt_pk_bf16_f32 v14, v14, v14
    v_and_b32 v14, 0xffff0000, v14
    v_add_f32_dpp v10, v10, v10 row_ror:4 row_mask:0xf bank_mask:0xf
    v_sqrt_f32 v14, v14
    v_and_b32 v8, 0xffff, v8
    v_add_f32_dpp v10, v10, v10 row_ror:2 row_mask:0xf bank_mask:0xf
    v_cvt_pk_bf16_f32 v14, v14, v14
    v_and_b32 v14, 0xffff0000, v14
    v_add_f32_dpp v10, v10, v10 row_ror:1 row_mask:0xf bank_mask:0xf
    v_rcp_f32 v12, v14
    v_or_b32 v16, v8, v14
    v_mul_f32 v10, v10, v12
    v_cvt_pk_bf16_f32 v10, v10, v10
    v_bfe_i32 v11, v10, 15, 1
    v_or_b32 v11, 0x8000, v11
    v_xor_b32 v10, v10, v11
    v_lshlrev_b32 v10, 16, v10
    v_sub_u32 v11, 2047, v2
    v_or_b32 v18, v10, v11
    v_cmp_eq_u32 vcc, 0, v3
    s_nop 1
    v_cndmask_b32 v16, v18, v16, vcc
    v_lshlrev_b32 v5, 14, v3
    v_lshl_add_u32 v5, v2, 3, v5
    s_movk_i32 s14, 2048
    v_cmp_gt_u32 vcc, 2, v3
    v_cmp_gt_u32 s[12:13], s14, v2
    s_and_b64 s[70:71], vcc, s[12:13]
    s_waitcnt lgkmcnt(0)
    s_add_u32 s10, s10, 1
    v_mov_b32 v17, s10
    s_mov_b32 s11, 4096
    s_mov_b64 exec, s[70:71]
    s_cbranch_execz L_stend
    buffer_store_dwordx2 v[16:17], v5, s[52:55], s11 offen sc1
L_stend:
    s_mov_b64 exec, -1
L_gemm:
    s_setprio 3
    s_cmp_lg_u32 s5, 3
    s_cbranch_scc1 L_noones
    v_mov_b32 v8, 0x3f803f80
    v_mov_b32 v9, v8
    v_mov_b32 v10, v8
    v_mov_b32 v11, v8
    v_and_b32 v2, 15, v0
    v_lshlrev_b32 v2, 4, v2
    v_lshrrev_b32 v3, 4, v0
    v_min_u32 v3, 3, v3
    v_mul_u32_u24 v3, 38912, v3
    v_add_u32 v2, v2, v3
    ds_write_b128 v2, v[8:11]
    s_waitcnt lgkmcnt(0)
L_noones:
    v_and_b32 v1, 15, v0
    v_lshrrev_b32 v2, 4, v0
    v_lshrrev_b32 v3, 1, v1
    v_xor_b32 v3, v2, v3
    v_lshlrev_b32 v3, 4, v3
    v_lshl_add_u32 v8, v1, 7, v3
    v_xor_b32 v9, 64, v8
    v_lshrrev_b32 v3, 2, v1
    v_and_b32 v14, 3, v1
    v_lshrrev_b32 v15, 1, v3
    v_and_b32 v10, 1, v2
    v_lshl_or_b32 v15, v10, 1, v15
    v_xor_b32 v15, s5, v15
    v_lshl_add_u32 v3, v2, 3, v3
    v_lshlrev_b32 v3, 7, v3
    v_lshl_add_u32 v3, v15, 5, v3
    v_lshl_add_u32 v3, v14, 3, v3
    v_add_u32 v10, 14336, v3
    v_add_u32 v11, 38912, v8
    v_add_u32 v12, 38912, v9
    v_add_u32 v13, 38912, v10
    v_lshlrev_b32 v14, 3, v1
    v_add_u32 v14, 157952, v14
    s_lshl_b32 s11, s5, 2
    s_add_u32 s11, s11, s7
    v_add_u32 v3, s11, v2
    v_mul_u32_u24 v15, 496, v1
    v_lshl_add_u32 v15, v3, 3, v15
    v_mov_b32 v6, 158848
    v_mov_b32 v7, 1
    s_mov_b32 s78, 1
    s_mov_b32 s79, 77824
    s_barrier
    ds_read_b64_tr_b16 v[128:129], v13 offset:0
    ds_read_b64_tr_b16 v[130:131], v13 offset:512
    ds_read_b64_tr_b16 v[132:133], v13 offset:8192
    ds_read_b64_tr_b16 v[134:135], v13 offset:8704
    ds_read_b64_tr_b16 v[136:137], v13 offset:16384
    ds_read_b64_tr_b16 v[138:139], v13 offset:16896
    ds_read_b128 v[100:103], v11 offset:0
    ds_read_b128 v[104:107], v11 offset:2048
    ds_read_b128 v[108:111], v11 offset:4096
    ds_read_b128 v[112:115], v11 offset:6144
    ds_read_b128 v[116:119], v11 offset:8192
    ds_read_b128 v[120:123], v11 offset:10240
    ds_read_b128 v[124:127], v11 offset:12288
    s_cmp_lg_u32 s5, 3
    s_cbranch_scc1 L_cnt_15
    s_lshl_b32 s11, s3, 5
    s_add_u32 s11, s11, s4
    s_lshl_b32 s11, s11, 2
    s_add_u32 s11, s11, 3014656
    v_mov_b32 v4, s11
    s_getreg_b32 s11, hwreg(HW_REG_XCC_ID, 0, 4)
    s_lshl_b32 s11, s11, 28
    s_xor_b32 s11, s11, s10
    v_mov_b32 v5, s11
    s_mov_b64 exec, 1
    buffer_store_dword v5, v4, s[52:55], 0 offen sc1
    s_mov_b64 exec, -1
L_cnt_15:
    s_waitcnt lgkmcnt(0)
    v_mfma_f32_16x16x32_bf16 v[16:19], v[128:131], v[100:103], 0
    ds_read_b64_tr_b16 v[168:169], v13 offset:4096
    v_mfma_f32_16x16x32_bf16 v[44:47], v[132:135], v[100:103], 0
    ds_read_b64_tr_b16 v[170:171], v13 offset:4608
    v_mfma_f32_16x16x32_bf16 v[72:75], v[136:139], v[100:103], 0
    ds_read_b64_tr_b16 v[172:173], v13 offset:12288
    v_mfma_f32_16x16x32_bf16 v[20:23], v[128:131], v[104:107], 0
    ds_read_b64_tr_b16 v[174:175], v13 offset:12800
    v_mfma_f32_16x16x32_bf16 v[48:51], v[132:135], v[104:107], 0
    ds_read_b64_tr_b16 v[176:177], v13 offset:20480
    v_mfma_f32_16x16x32_bf16 v[76:79], v[136:139], v[104:107], 0
    ds_read_b64_tr_b16 v[178:179], v13 offset:20992
    v_mfma_f32_16x16x32_bf16 v[24:27], v[128:131], v[108:111], 0
    ds_read_b128 v[140:143], v12 offset:0
    v_mfma_f32_16x16x32_bf16 v[52:55], v[132:135], v[108:111], 0
    ds_read_b128 v[144:147], v12 offset:2048
    v_mfma_f32_16x16x32_bf16 v[80:83], v[136:139], v[108:111], 0
    ds_read_b128 v[148:151], v12 offset:4096
    v_mfma_f32_16x16x32_bf16 v[28:31], v[128:131], v[112:115], 0
    ds_read_b128 v[152:155], v12 offset:6144
    v_mfma_f32_16x16x32_bf16 v[56:59], v[132:135], v[112:115], 0
    ds_read_b128 v[156:159], v12 offset:8192
    v_mfma_f32_16x16x32_bf16 v[84:87], v[136:139], v[112:115], 0
    ds_read_b128 v[160:163], v12 offset:10240
    v_mfma_f32_16x16x32_bf16 v[32:35], v[128:131], v[116:119], 0
    ds_read_b128 v[164:167], v12 offset:12288
    v_mfma_f32_16x16x32_bf16 v[60:63], v[132:135], v[116:119], 0
    v_add_u32 v11, s79, v8
    v_add_u32 v12, s79, v9
    v_mfma_f32_16x16x32_bf16 v[88:91], v[136:139], v[116:119], 0
    v_add_u32 v13, s79, v10
    s_add_u32 s79, s79, 38912
    v_mfma_f32_16x16x32_bf16 v[36:39], v[128:131], v[120:123], 0
    s_cmp_eq_u32 s79, 155648
    s_cselect_b32 s79, 0, s79
    v_mfma_f32_16x16x32_bf16 v[64:67], v[132:135], v[120:123], 0
    v_mfma_f32_16x16x32_bf16 v[92:95], v[136:139], v[120:123], 0
    v_mfma_f32_16x16x32_bf16 v[40:43], v[128:131], v[124:127], 0
    v_mfma_f32_16x16x32_bf16 v[68:71], v[132:135], v[124:127], 0
    s_waitcnt lgkmcnt(0)
    v_mfma_f32_16x16x32_bf16 v[96:99], v[136:139], v[124:127], 0
L_kloop:
    s_barrier
    v_mfma_f32_16x16x32_bf16 v[16:19], v[168:171], v[140:143], v[16:19]
    ds_read_b64_tr_b16 v[128:129], v13 offset:0
    v_mfma_f32_16x16x32_bf16 v[44:47], v[172:175], v[140:143], v[44:47]
    ds_read_b64_tr_b16 v[130:131], v13 offset:512
    v_mfma_f32_16x16x32_bf16 v[72:75], v[176:179], v[140:143], v[72:75]
    ds_read_b64_tr_b16 v[132:133], v13 offset:8192
    v_mfma_f32_16x16x32_bf16 v[20:23], v[168:171], v[144:147], v[20:23]
    ds_read_b64_tr_b16 v[134:135], v13 offset:8704
    v_mfma_f32_16x16x32_bf16 v[48:51], v[172:175], v[144:147], v[48:51]
    ds_read_b64_tr_b16 v[136:137], v13 offset:16384
    v_mfma_f32_16x16x32_bf16 v[76:79], v[176:179], v[144:147], v[76:79]
    ds_read_b64_tr_b16 v[138:139], v13 offset:16896
    v_mfma_f32_16x16x32_bf16 v[24:27], v[168:171], v[148:151], v[24:27]
    ds_read_b128 v[100:103], v11 offset:0
    v_mfma_f32_16x16x32_bf16 v[52:55], v[172:175], v[148:151], v[52:55]
    ds_read_b128 v[104:107], v11 offset:2048
    v_mfma_f32_16x16x32_bf16 v[80:83], v[176:179], v[148:151], v[80:83]
    ds_read_b128 v[108:111], v11 offset:4096
    v_mfma_f32_16x16x32_bf16 v[28:31], v[168:171], v[152:155], v[28:31]
    ds_read_b128 v[112:115], v11 offset:6144
    v_mfma_f32_16x16x32_bf16 v[56:59], v[172:175], v[152:155], v[56:59]
    ds_read_b128 v[116:119], v11 offset:8192
    v_mfma_f32_16x16x32_bf16 v[84:87], v[176:179], v[152:155], v[84:87]
    ds_read_b128 v[120:123], v11 offset:10240
    v_mfma_f32_16x16x32_bf16 v[32:35], v[168:171], v[156:159], v[32:35]
    ds_read_b128 v[124:127], v11 offset:12288
    v_mfma_f32_16x16x32_bf16 v[60:63], v[172:175], v[156:159], v[60:63]
    s_add_u32 s78, s78, 1
    s_cmp_ge_u32 s78, 10
    v_mfma_f32_16x16x32_bf16 v[88:91], v[176:179], v[156:159], v[88:91]
    v_mfma_f32_16x16x32_bf16 v[36:39], v[168:171], v[160:163], v[36:39]
    v_mfma_f32_16x16x32_bf16 v[64:67], v[172:175], v[160:163], v[64:67]
    v_mfma_f32_16x16x32_bf16 v[92:95], v[176:179], v[160:163], v[92:95]
    v_mfma_f32_16x16x32_bf16 v[40:43], v[168:171], v[164:167], v[40:43]
    v_mfma_f32_16x16x32_bf16 v[68:71], v[172:175], v[164:167], v[68:71]
    s_waitcnt lgkmcnt(0)
    v_mfma_f32_16x16x32_bf16 v[96:99], v[176:179], v[164:167], v[96:99]
    s_cbranch_scc1 L_ktail
    v_mfma_f32_16x16x32_bf16 v[16:19], v[128:131], v[100:103], v[16:19]
    ds_read_b64_tr_b16 v[168:169], v13 offset:4096
    v_mfma_f32_16x16x32_bf16 v[44:47], v[132:135], v[100:103], v[44:47]
    ds_read_b64_tr_b16 v[170:171], v13 offset:4608
    v_mfma_f32_16x16x32_bf16 v[72:75], v[136:139], v[100:103], v[72:75]
    ds_read_b64_tr_b16 v[172:173], v13 offset:12288
    v_mfma_f32_16x16x32_bf16 v[20:23], v[128:131], v[104:107], v[20:23]
    ds_read_b64_tr_b16 v[174:175], v13 offset:12800
    v_mfma_f32_16x16x32_bf16 v[48:51], v[132:135], v[104:107], v[48:51]
    ds_read_b64_tr_b16 v[176:177], v13 offset:20480
    v_mfma_f32_16x16x32_bf16 v[76:79], v[136:139], v[104:107], v[76:79]
    ds_read_b64_tr_b16 v[178:179], v13 offset:20992
    v_mfma_f32_16x16x32_bf16 v[24:27], v[128:131], v[108:111], v[24:27]
    ds_read_b128 v[140:143], v12 offset:0
    v_mfma_f32_16x16x32_bf16 v[52:55], v[132:135], v[108:111], v[52:55]
    ds_read_b128 v[144:147], v12 offset:2048
    v_mfma_f32_16x16x32_bf16 v[80:83], v[136:139], v[108:111], v[80:83]
    ds_read_b128 v[148:151], v12 offset:4096
    v_mfma_f32_16x16x32_bf16 v[28:31], v[128:131], v[112:115], v[28:31]
    ds_read_b128 v[152:155], v12 offset:6144
    v_mfma_f32_16x16x32_bf16 v[56:59], v[132:135], v[112:115], v[56:59]
    ds_read_b128 v[156:159], v12 offset:8192
    v_mfma_f32_16x16x32_bf16 v[84:87], v[136:139], v[112:115], v[84:87]
    ds_read_b128 v[160:163], v12 offset:10240
    v_mfma_f32_16x16x32_bf16 v[32:35], v[128:131], v[116:119], v[32:35]
    ds_read_b128 v[164:167], v12 offset:12288
    v_mfma_f32_16x16x32_bf16 v[60:63], v[132:135], v[116:119], v[60:63]
    v_add_u32 v11, s79, v8
    v_add_u32 v12, s79, v9
    v_mfma_f32_16x16x32_bf16 v[88:91], v[136:139], v[116:119], v[88:91]
    v_add_u32 v13, s79, v10
    s_add_u32 s79, s79, 38912
    v_mfma_f32_16x16x32_bf16 v[36:39], v[128:131], v[120:123], v[36:39]
    s_cmp_eq_u32 s79, 155648
    s_cselect_b32 s79, 0, s79
    v_mfma_f32_16x16x32_bf16 v[64:67], v[132:135], v[120:123], v[64:67]
    v_mfma_f32_16x16x32_bf16 v[92:95], v[136:139], v[120:123], v[92:95]
    v_mfma_f32_16x16x32_bf16 v[40:43], v[128:131], v[124:127], v[40:43]
    v_mfma_f32_16x16x32_bf16 v[68:71], v[132:135], v[124:127], v[68:71]
    s_waitcnt lgkmcnt(0)
    v_mfma_f32_16x16x32_bf16 v[96:99], v[136:139], v[124:127], v[96:99]
    s_branch L_kloop
L_ktail:
    v_mfma_f32_16x16x32_bf16 v[16:19], v[128:131], v[100:103], v[16:19]
    ds_read_b64_tr_b16 v[168:169], v13 offset:4096
    ds_read_b64_tr_b16 v[170:171], v13 offset:4608
    s_mov_b32 s64, 0xaaaaaaaa
    s_mov_b32 s65, 0xaaaaaaaa
    s_mov_b32 s66, 0xfff0ffff
    s_mov_b32 s67, 0xf000ff00
    v_mfma_f32_16x16x32_bf16 v[20:23], v[128:131], v[104:107], v[20:23]
    ds_read_b128 v[140:143], v12 offset:0
    ds_read_b128 v[144:147], v12 offset:2048
    s_mov_b32 s68, 0xffc0fffc
    s_mov_b32 s69, 0xc000fc00
    s_getreg_b32 s74, hwreg(HW_REG_XCC_ID, 0, 4)
    s_lshl_b32 s74, s74, 12
    v_mfma_f32_16x16x32_bf16 v[24:27], v[128:131], v[108:111], v[24:27]
    ds_read_b128 v[148:151], v12 offset:4096
    ds_read_b128 v[152:155], v12 offset:6144
    s_xor_b32 s74, s74, s10
    s_and_b32 s74, s74, 0xffff
    s_and_b32 s75, s74, 0xff
    s_lshr_b32 s39, s74, 8
    v_mfma_f32_16x16x32_bf16 v[28:31], v[128:131], v[112:115], v[28:31]
    ds_read_b128 v[156:159], v12 offset:8192
    ds_read_b128 v[160:163], v12 offset:10240
    s_mul_i32 s12, s6, 10
    s_add_u32 s12, s12, s8
    s_mul_i32 s12, s12, 12
    s_add_u32 s12, s12, s5
    v_mfma_f32_16x16x32_bf16 v[32:35], v[128:131], v[116:119], v[32:35]
    ds_read_b128 v[164:167], v12 offset:12288
    ds_read_b64_tr_b16 v[172:173], v13 offset:12288
    s_lshl_b32 s12, s12, 9
    s_add_u32 s12, s12, 65536
    s_mov_b32 s13, 0x7f000000
    s_sub_u32 s14, s12, 3072
    v_mfma_f32_16x16x32_bf16 v[36:39], v[128:131], v[120:123], v[36:39]
    ds_read_b64_tr_b16 v[174:175], v13 offset:12800
    ds_read_b64_tr_b16 v[176:177], v13 offset:20480
    s_cmp_ge_u32 s7, 1
    s_cselect_b32 s70, s12, s13
    s_cselect_b32 s72, s14, s13
    s_cselect_b32 s76, s74, 0
    v_mfma_f32_16x16x32_bf16 v[40:43], v[128:131], v[124:127], v[40:43]
    ds_read_b64_tr_b16 v[178:179], v13 offset:20992
    ds_read_b64 v[180:181], v14 offset:0
    s_add_u32 s14, s12, 3072
    s_add_u32 s12, s12, 6144
    s_cmp_le_u32 s7, 3
    s_cselect_b32 s71, s14, s13
    v_mfma_f32_16x16x32_bf16 v[44:47], v[132:135], v[100:103], v[44:47]
    ds_read_b64 v[182:183], v14 offset:128
    ds_read_b64 v[184:185], v14 offset:256
    s_cselect_b32 s73, s12, s13
    s_cselect_b32 s77, s74, 0
    s_lshl_b32 s11, s7, 3
    s_lshl_b64 s[28:29], -1, s11
    v_mfma_f32_16x16x32_bf16 v[48:51], v[132:135], v[104:107], v[48:51]
    ds_read_b64 v[186:187], v14 offset:384
    ds_read_b64 v[188:189], v14 offset:512
    s_lshl_b64 s[28:29], s[28:29], s11
    s_mul_i32 s12, s6, 6
    s_add_u32 s12, s12, s5
    s_lshr_b32 s11, s12, 4
    v_mfma_f32_16x16x32_bf16 v[52:55], v[132:135], v[108:111], v[52:55]
    ds_read_b64 v[190:191], v14 offset:640
    ds_read_b64 v[192:193], v14 offset:768
    s_cmp_eq_u32 s11, s3
    s_cselect_b32 s31, 1, 0
    s_mul_i32 s14, s12, 10
    s_add_u32 s14, s14, s8
    v_mfma_f32_16x16x32_bf16 v[56:59], v[132:135], v[112:115], v[56:59]
    s_lshl_b32 s25, s14, 11
    s_add_u32 s25, s25, 3145728
    s_lshl_b32 s26, s14, 7
    s_add_u32 s26, s26, 2818048
    v_mfma_f32_16x16x32_bf16 v[60:63], v[132:135], v[116:119], v[60:63]
    s_cmpk_ge_u32 s12, 128
    s_cselect_b32 s25, s13, s25
    s_cselect_b32 s26, s13, s26
    s_mov_b32 s38, 3
    v_mfma_f32_16x16x32_bf16 v[64:67], v[132:135], v[120:123], v[64:67]
    v_mfma_f32_16x16x32_bf16 v[68:71], v[132:135], v[124:127], v[68:71]
    s_waitcnt lgkmcnt(11)
    v_mfma_f32_16x16x32_bf16 v[16:19], v[168:171], v[140:143], v[16:19]
    v_mfma_f32_16x16x32_bf16 v[20:23], v[168:171], v[144:147], v[20:23]
    v_mfma_f32_16x16x32_bf16 v[24:27], v[168:171], v[148:151], v[24:27]
    s_waitcnt lgkmcnt(0)
    s_mov_b64 exec, 1
    ds_add_u32 v6, v7 offset:8
    s_mov_b64 exec, -1
    v_mfma_f32_16x16x32_bf16 v[28:31], v[168:171], v[152:155], v[28:31]
    v_mov_b32 v216, v183
    v_mfma_f32_16x16x32_bf16 v[32:35], v[168:171], v[156:159], v[32:35]
    v_mov_b32 v218, v185
    v_mov_b32_dpp v128, v16 row_newbcast:0 row_mask:0xf bank_mask:0xf
    v_mov_b32_dpp v129, v17 row_newbcast:0 row_mask:0xf bank_mask:0xf
    v_mov_b32_dpp v130, v18 row_newbcast:0 row_mask:0xf bank_mask:0xf
    v_mov_b32_dpp v131, v19 row_newbcast:0 row_mask:0xf bank_mask:0xf
    v_mfma_f32_16x16x32_bf16 v[36:39], v[168:171], v[160:163], v[36:39]
    v_mov_b32 v220, v187
    v_pk_mul_f32 v[20:21], v[20:21], v[182:183] op_sel_hi:[1,0]
    v_pk_mul_f32 v[22:23], v[22:23], v[182:183] op_sel_hi:[1,0]
    v_pk_fma_f32 v[20:21], v[128:129], v[216:217], v[20:21] op_sel_hi:[1,0,1]
    v_pk_fma_f32 v[22:23], v[130:131], v[216:217], v[22:23] op_sel_hi:[1,0,1]
    v_mfma_f32_16x16x32_bf16 v[40:43], v[168:171], v[164:167], v[40:43]
    v_mov_b32 v222, v189
    v_cvt_pk_bf16_f32 v20, v20, v21
    v_cvt_pk_bf16_f32 v21, v22, v23
    ds_write_b64 v15, v[20:21] offset:7936
    v_pk_mul_f32 v[24:25], v[24:25], v[184:185] op_sel_hi:[1,0]
    v_mfma_f32_16x16x32_bf16 v[44:47], v[172:175], v[140:143], v[44:47]
    v_mov_b32 v224, v191
    v_pk_mul_f32 v[26:27], v[26:27], v[184:185] op_sel_hi:[1,0]
    v_pk_fma_f32 v[24:25], v[128:129], v[218:219], v[24:25] op_sel_hi:[1,0,1]
    v_pk_fma_f32 v[26:27], v[130:131], v[218:219], v[26:27] op_sel_hi:[1,0,1]
    v_cvt_pk_bf16_f32 v24, v24, v25
    v_mfma_f32_16x16x32_bf16 v[48:51], v[172:175], v[144:147], v[48:51]
    v_mov_b32 v226, v193
    v_cvt_pk_bf16_f32 v25, v26, v27
    ds_write_b64 v15, v[24:25] offset:15872
    v_pk_mul_f32 v[28:29], v[28:29], v[186:187] op_sel_hi:[1,0]
    v_pk_mul_f32 v[30:31], v[30:31], v[186:187] op_sel_hi:[1,0]
    v_mfma_f32_16x16x32_bf16 v[52:55], v[172:175], v[148:151], v[52:55]
    v_mov_b32 v194, v181
    v_pk_fma_f32 v[28:29], v[128:129], v[220:221], v[28:29] op_sel_hi:[1,0,1]
    v_pk_fma_f32 v[30:31], v[130:131], v[220:221], v[30:31] op_sel_hi:[1,0,1]
    v_cvt_pk_bf16_f32 v28, v28, v29
    v_cvt_pk_bf16_f32 v29, v30, v31
    v_mfma_f32_16x16x32_bf16 v[56:59], v[172:175], v[152:155], v[56:59]
    ds_write_b64 v15, v[28:29] offset:23808
    v_pk_mul_f32 v[32:33], v[32:33], v[188:189] op_sel_hi:[1,0]
    v_pk_mul_f32 v[34:35], v[34:35], v[188:189] op_sel_hi:[1,0]
    v_pk_fma_f32 v[32:33], v[128:129], v[222:223], v[32:33] op_sel_hi:[1,0,1]
    v_mfma_f32_16x16x32_bf16 v[60:63], v[172:175], v[156:159], v[60:63]
    v_pk_fma_f32 v[34:35], v[130:131], v[222:223], v[34:35] op_sel_hi:[1,0,1]
    v_cvt_pk_bf16_f32 v32, v32, v33
    v_cvt_pk_bf16_f32 v33, v34, v35
    ds_write_b64 v15, v[32:33] offset:31744
    v_mfma_f32_16x16x32_bf16 v[64:67], v[172:175], v[160:163], v[64:67]
    v_pk_mul_f32 v[36:37], v[36:37], v[190:191] op_sel_hi:[1,0]
    v_pk_mul_f32 v[38:39], v[38:39], v[190:191] op_sel_hi:[1,0]
    v_pk_fma_f32 v[36:37], v[128:129], v[224:225], v[36:37] op_sel_hi:[1,0,1]
    v_pk_fma_f32 v[38:39], v[130:131], v[224:225], v[38:39] op_sel_hi:[1,0,1]
    v_mfma_f32_16x16x32_bf16 v[68:71], v[172:175], v[164:167], v[68:71]
    v_cvt_pk_bf16_f32 v36, v36, v37
    v_cvt_pk_bf16_f32 v37, v38, v39
    ds_write_b64 v15, v[36:37] offset:39680
    v_pk_mul_f32 v[40:41], v[40:41], v[192:193] op_sel_hi:[1,0]
    v_mfma_f32_16x16x32_bf16 v[72:75], v[136:139], v[100:103], v[72:75]
    v_pk_mul_f32 v[42:43], v[42:43], v[192:193] op_sel_hi:[1,0]
    v_pk_fma_f32 v[40:41], v[128:129], v[226:227], v[40:41] op_sel_hi:[1,0,1]
    v_pk_fma_f32 v[42:43], v[130:131], v[226:227], v[42:43] op_sel_hi:[1,0,1]
    v_cvt_pk_bf16_f32 v40, v40, v41
    v_mfma_f32_16x16x32_bf16 v[76:79], v[136:139], v[104:107], v[76:79]
    v_cvt_pk_bf16_f32 v41, v42, v43
    ds_write_b64 v15, v[40:41] offset:47616
    v_mov_b32_dpp v132, v44 row_newbcast:0 row_mask:0xf bank_mask:0xf
    v_mov_b32_dpp v133, v45 row_newbcast:0 row_mask:0xf bank_mask:0xf
    v_mfma_f32_16x16x32_bf16 v[80:83], v[136:139], v[108:111], v[80:83]
    v_mov_b32_dpp v134, v46 row_newbcast:0 row_mask:0xf bank_mask:0xf
    v_mov_b32_dpp v135, v47 row_newbcast:0 row_mask:0xf bank_mask:0xf
    v_pk_mul_f32 v[44:45], v[44:45], v[180:181] op_sel_hi:[1,0]
    v_pk_mul_f32 v[46:47], v[46:47], v[180:181] op_sel_hi:[1,0]
    v_mfma_f32_16x16x32_bf16 v[84:87], v[136:139], v[112:115], v[84:87]
    v_pk_fma_f32 v[44:45], v[132:133], v[194:195], v[44:45] op_sel_hi:[1,0,1]
    v_pk_fma_f32 v[46:47], v[134:135], v[194:195], v[46:47] op_sel_hi:[1,0,1]
    v_cvt_pk_bf16_f32 v44, v44, v45
    v_cvt_pk_bf16_f32 v45, v46, v47
    v_mfma_f32_16x16x32_bf16 v[88:91], v[136:139], v[116:119], v[88:91]
    ds_write_b64 v15, v[44:45] offset:160
    v_pk_mul_f32 v[48:49], v[48:49], v[182:183] op_sel_hi:[1,0]
    v_pk_mul_f32 v[50:51], v[50:51], v[182:183] op_sel_hi:[1,0]
    v_pk_fma_f32 v[48:49], v[132:133], v[216:217], v[48:49] op_sel_hi:[1,0,1]
    v_mfma_f32_16x16x32_bf16 v[92:95], v[136:139], v[120:123], v[92:95]
    v_pk_fma_f32 v[50:51], v[134:135], v[216:217], v[50:51] op_sel_hi:[1,0,1]
    v_cvt_pk_bf16_f32 v48, v48, v49
    v_cvt_pk_bf16_f32 v49, v50, v51
    ds_write_b64 v15, v[48:49] offset:8096
    v_mfma_f32_16x16x32_bf16 v[96:99], v[136:139], v[124:127], v[96:99]
    v_pk_mul_f32 v[52:53], v[52:53], v[184:185] op_sel_hi:[1,0]
    v_pk_mul_f32 v[54:55], v[54:55], v[184:185] op_sel_hi:[1,0]
    v_pk_fma_f32 v[52:53], v[132:133], v[218:219], v[52:53] op_sel_hi:[1,0,1]
    v_pk_fma_f32 v[54:55], v[134:135], v[218:219], v[54:55] op_sel_hi:[1,0,1]
    v_mfma_f32_16x16x32_bf16 v[72:75], v[176:179], v[140:143], v[72:75]
    v_cvt_pk_bf16_f32 v52, v52, v53
    v_cvt_pk_bf16_f32 v53, v54, v55
    ds_write_b64 v15, v[52:53] offset:16032
    v_pk_mul_f32 v[56:57], v[56:57], v[186:187] op_sel_hi:[1,0]
    v_mfma_f32_16x16x32_bf16 v[76:79], v[176:179], v[144:147], v[76:79]
    v_pk_mul_f32 v[58:59], v[58:59], v[186:187] op_sel_hi:[1,0]
    v_pk_fma_f32 v[56:57], v[132:133], v[220:221], v[56:57] op_sel_hi:[1,0,1]
    v_pk_fma_f32 v[58:59], v[134:135], v[220:221], v[58:59] op_sel_hi:[1,0,1]
    v_cvt_pk_bf16_f32 v56, v56, v57
    v_mfma_f32_16x16x32_bf16 v[80:83], v[176:179], v[148:151], v[80:83]
    v_cvt_pk_bf16_f32 v57, v58, v59
    ds_write_b64 v15, v[56:57] offset:23968
    v_pk_mul_f32 v[60:61], v[60:61], v[188:189] op_sel_hi:[1,0]
    v_pk_mul_f32 v[62:63], v[62:63], v[188:189] op_sel_hi:[1,0]
    v_mfma_f32_16x16x32_bf16 v[84:87], v[176:179], v[152:155], v[84:87]
    v_pk_fma_f32 v[60:61], v[132:133], v[222:223], v[60:61] op_sel_hi:[1,0,1]
    v_pk_fma_f32 v[62:63], v[134:135], v[222:223], v[62:63] op_sel_hi:[1,0,1]
    v_cvt_pk_bf16_f32 v60, v60, v61
    v_cvt_pk_bf16_f32 v61, v62, v63
    v_mfma_f32_16x16x32_bf16 v[88:91], v[176:179], v[156:159], v[88:91]
    ds_write_b64 v15, v[60:61] offset:31904
    v_pk_mul_f32 v[64:65], v[64:65], v[190:191] op_sel_hi:[1,0]
    v_pk_mul_f32 v[66:67], v[66:67], v[190:191] op_sel_hi:[1,0]
    v_pk_fma_f32 v[64:65], v[132:133], v[224:225], v[64:65] op_sel_hi:[1,0,1]
    v_mfma_f32_16x16x32_bf16 v[92:95], v[176:179], v[160:163], v[92:95]
    v_pk_fma_f32 v[66:67], v[134:135], v[224:225], v[66:67] op_sel_hi:[1,0,1]
    v_cvt_pk_bf16_f32 v64, v64, v65
    v_cvt_pk_bf16_f32 v65, v66, v67
    ds_write_b64 v15, v[64:65] offset:39840
    v_mfma_f32_16x16x32_bf16 v[96:99], v[176:179], v[164:167], v[96:99]
    v_pk_mul_f32 v[68:69], v[68:69], v[192:193] op_sel_hi:[1,0]
    v_pk_mul_f32 v[70:71], v[70:71], v[192:193] op_sel_hi:[1,0]
    v_pk_fma_f32 v[68:69], v[132:133], v[226:227], v[68:69] op_sel_hi:[1,0,1]
    v_pk_fma_f32 v[70:71], v[134:135], v[226:227], v[70:71] op_sel_hi:[1,0,1]
    v_cvt_pk_bf16_f32 v68, v68, v69
    v_cvt_pk_bf16_f32 v69, v70, v71
    ds_write_b64 v15, v[68:69] offset:47776
L_img:
    s_mov_b64 exec, 1
    ds_add_u32 v6, v7 offset:12
    s_mov_b64 exec, -1
L_img2:
    v_mov_b32 v8, 158848
    s_mov_b32 s15, 1600000
L_imw:
    ds_read_b32 v3, v8 offset:12
    s_waitcnt lgkmcnt(0)
    v_readfirstlane_b32 s11, v3
    s_cmp_ge_u32 s11, 8
    s_cbranch_scc1 L_imok
    s_sleep 1
    s_sub_u32 s15, s15, 1
    s_cmp_lg_u32 s15, 0
    s_cbranch_scc1 L_imw
L_imok:
    s_setprio 3
    s_mov_b32 exec_hi, 0
    ds_read_b64 v[196:197], v228 offset:0
    ds_read_b64 v[208:209], v228 offset:120
    s_mov_b32 exec_hi, 0xffff
    ds_read_b64 v[198:199], v228 offset:16
    ds_read_b64 v[210:211], v228 offset:136
    s_mov_b64 exec, -1
    ds_read_b64 v[16:17], v228 offset:160
    ds_read_b64 v[18:19], v228 offset:176
    ds_read_b64 v[20:21], v231 offset:160
    ds_read_b64 v[22:23], v231 offset:176
    ds_read_b64 v[40:41], v228 offset:280
    ds_read_b64 v[42:43], v228 offset:296
    ds_read_b64 v[44:45], v231 offset:280
    ds_read_b64 v[46:47], v231 offset:296
    v_mov_b32 v9, 0xffffff00
    v_lshlrev_b32 v230, 3, v0
    v_mov_b32 v10, 0x0c0c0400
    s_waitcnt lgkmcnt(4)
    v_mfma_f32_16x16x32_bf16 v[100:103], v[16:19], v[196:199], 0
    v_mfma_f32_16x16x32_bf16 v[104:107], v[20:23], v[196:199], 0
    s_waitcnt lgkmcnt(0)
    v_mfma_f32_16x16x32_bf16 v[124:127], v[40:43], v[208:211], 0
    v_mfma_f32_16x16x32_bf16 v[128:131], v[44:47], v[208:211], 0
    s_mov_b32 exec_hi, 0
    ds_read_b64 v[200:201], v228 offset:40
    ds_read_b64 v[204:205], v228 offset:80
    s_mov_b32 exec_hi, 0xffff
    ds_read_b64 v[202:203], v228 offset:56
    ds_read_b64 v[206:207], v228 offset:96
    s_mov_b64 exec, -1
    ds_read_b64 v[24:25], v228 offset:200
    ds_read_b64 v[26:27], v228 offset:216
    ds_read_b64 v[28:29], v231 offset:200
    ds_read_b64 v[30:31], v231 offset:216
    v_cndmask_b32 v100, v100, v101, s[64:65]
    v_cndmask_b32 v102, v102, v103, s[64:65]
    v_cndmask_b32 v104, v104, v105, s[64:65]
    v_cndmask_b32 v106, v106, v107, s[64:65]
    v_cndmask_b32 v132, v104, v100, s[66:67]
    v_cndmask_b32 v133, v106, v102, s[68:69]
    v_and_or_b32 v134, v132, v9, s75
    v_and_or_b32 v135, v133, v9, s39
    buffer_store_dwordx2 v[134:135], v230, s[52:55], s70 offen nt
    v_cndmask_b32 v124, v124, v125, s[64:65]
    v_cndmask_b32 v126, v126, v127, s[64:65]
    v_cndmask_b32 v128, v128, v129, s[64:65]
    v_cndmask_b32 v130, v130, v131, s[64:65]
    v_cndmask_b32 v144, v128, v124, s[66:67]
    v_cndmask_b32 v145, v130, v126, s[68:69]
    v_and_or_b32 v146, v144, v9, s75
    v_and_or_b32 v147, v145, v9, s39
    buffer_store_dwordx2 v[146:147], v230, s[52:55], s71 offen nt
    ds_read_b64 v[32:33], v228 offset:240
    ds_read_b64 v[34:35], v228 offset:256
    ds_read_b64 v[36:37], v231 offset:240
    ds_read_b64 v[38:39], v231 offset:256
    s_waitcnt lgkmcnt(4)
    v_mfma_f32_16x16x32_bf16 v[108:111], v[24:27], v[200:203], 0
    v_mfma_f32_16x16x32_bf16 v[112:115], v[28:31], v[200:203], 0
    s_waitcnt lgkmcnt(0)
    v_mfma_f32_16x16x32_bf16 v[116:119], v[32:35], v[204:207], 0
    v_mfma_f32_16x16x32_bf16 v[120:123], v[36:39], v[204:207], 0
    s_nop 3
    v_cndmask_b32 v108, v108, v109, s[64:65]
    v_cndmask_b32 v110, v110, v111, s[64:65]
    v_cndmask_b32 v112, v112, v113, s[64:65]
    v_cndmask_b32 v114, v114, v115, s[64:65]
    v_cndmask_b32 v136, v112, v108, s[66:67]
    v_cndmask_b32 v137, v114, v110, s[68:69]
    v_cndmask_b32 v116, v116, v117, s[64:65]
    v_cndmask_b32 v118, v118, v119, s[64:65]
    v_cndmask_b32 v120, v120, v121, s[64:65]
    v_cndmask_b32 v122, v122, v123, s[64:65]
    v_cndmask_b32 v140, v120, v116, s[66:67]
    v_cndmask_b32 v141, v122, v118, s[68:69]
    v_mov_b32 v12, 0x3ea52b5c
    s_cmp_ge_u32 s5, 4
    s_cbranch_scc1 L_nov
    v_mov_b32_dpp v168, v72 row_newbcast:0 row_mask:0xf bank_mask:0xf
    v_mov_b32_dpp v169, v73 row_newbcast:0 row_mask:0xf bank_mask:0xf
    v_mov_b32_dpp v170, v74 row_newbcast:0 row_mask:0xf bank_mask:0xf
    v_mov_b32_dpp v171, v75 row_newbcast:0 row_mask:0xf bank_mask:0xf
    v_pk_mul_f32 v[72:73], v[72:73], v[180:181] op_sel_hi:[1,0]
    v_pk_mul_f32 v[74:75], v[74:75], v[180:181] op_sel_hi:[1,0]
    v_pk_fma_f32 v[72:73], v[168:169], v[194:195], v[72:73] op_sel_hi:[1,0,1]
    v_pk_fma_f32 v[74:75], v[170:171], v[194:195], v[74:75] op_sel_hi:[1,0,1]
    v_cvt_pk_bf16_f32 v72, v72, v73
    v_cvt_pk_bf16_f32 v73, v74, v75
    ds_write_b64 v15, v[72:73] offset:320
    buffer_load_dwordx2 v[148:149], v230, s[52:55], s72 offen sc1
    buffer_load_dwordx2 v[152:153], v230, s[52:55], s73 offen sc1
    v_pk_mul_f32 v[76:77], v[76:77], v[182:183] op_sel_hi:[1,0]
    v_pk_mul_f32 v[78:79], v[78:79], v[182:183] op_sel_hi:[1,0]
    v_pk_fma_f32 v[76:77], v[168:169], v[216:217], v[76:77] op_sel_hi:[1,0,1]
    v_pk_fma_f32 v[78:79], v[170:171], v[216:217], v[78:79] op_sel_hi:[1,0,1]
    v_cvt_pk_bf16_f32 v76, v76, v77
    v_cvt_pk_bf16_f32 v77, v78, v79
    ds_write_b64 v15, v[76:77] offset:8256
    v_pk_mul_f32 v[80:81], v[80:81], v[184:185] op_sel_hi:[1,0]
    v_pk_mul_f32 v[82:83], v[82:83], v[184:185] op_sel_hi:[1,0]
    v_pk_fma_f32 v[80:81], v[168:169], v[218:219], v[80:81] op_sel_hi:[1,0,1]
    v_pk_fma_f32 v[82:83], v[170:171], v[218:219], v[82:83] op_sel_hi:[1,0,1]
    v_cvt_pk_bf16_f32 v80, v80, v81
    v_cvt_pk_bf16_f32 v81, v82, v83
    ds_write_b64 v15, v[80:81] offset:16192
    v_pk_mul_f32 v[84:85], v[84:85], v[186:187] op_sel_hi:[1,0]
    v_pk_mul_f32 v[86:87], v[86:87], v[186:187] op_sel_hi:[1,0]
    v_pk_fma_f32 v[84:85], v[168:169], v[220:221], v[84:85] op_sel_hi:[1,0,1]
    v_pk_fma_f32 v[86:87], v[170:171], v[220:221], v[86:87] op_sel_hi:[1,0,1]
    v_cvt_pk_bf16_f32 v84, v84, v85
    v_cvt_pk_bf16_f32 v85, v86, v87
    ds_write_b64 v15, v[84:85] offset:24128
    v_pk_mul_f32 v[88:89], v[88:89], v[188:189] op_sel_hi:[1,0]
    v_pk_mul_f32 v[90:91], v[90:91], v[188:189] op_sel_hi:[1,0]
    v_pk_fma_f32 v[88:89], v[168:169], v[222:223], v[88:89] op_sel_hi:[1,0,1]
    v_pk_fma_f32 v[90:91], v[170:171], v[222:223], v[90:91] op_sel_hi:[1,0,1]
    v_cvt_pk_bf16_f32 v88, v88, v89
    v_cvt_pk_bf16_f32 v89, v90, v91
    ds_write_b64 v15, v[88:89] offset:32064
    v_pk_mul_f32 v[92:93], v[92:93], v[190:191] op_sel_hi:[1,0]
    v_pk_mul_f32 v[94:95], v[94:95], v[190:191] op_sel_hi:[1,0]
    v_pk_fma_f32 v[92:93], v[168:169], v[224:225], v[92:93] op_sel_hi:[1,0,1]
    v_pk_fma_f32 v[94:95], v[170:171], v[224:225], v[94:95] op_sel_hi:[1,0,1]
    v_cvt_pk_bf16_f32 v92, v92, v93
    v_cvt_pk_bf16_f32 v93, v94, v95
    ds_write_b64 v15, v[92:93] offset:40000
    v_pk_mul_f32 v[96:97], v[96:97], v[192:193] op_sel_hi:[1,0]
    v_pk_mul_f32 v[98:99], v[98:99], v[192:193] op_sel_hi:[1,0]
    v_pk_fma_f32 v[96:97], v[168:169], v[226:227], v[96:97] op_sel_hi:[1,0,1]
    v_pk_fma_f32 v[98:99], v[170:171], v[226:227], v[98:99] op_sel_hi:[1,0,1]
    v_cvt_pk_bf16_f32 v96, v96, v97
    v_cvt_pk_bf16_f32 v97, v98, v99
    ds_write_b64 v15, v[96:97] offset:47936
    s_mov_b64 exec, 1
    ds_add_u32 v6, v7
    s_mov_b64 exec, -1
    s_setprio 2
    s_branch L_nov2
L_nov:
    s_setprio 1
    buffer_load_dwordx2 v[148:149], v230, s[52:55], s72 offen sc1
    buffer_load_dwordx2 v[152:153], v230, s[52:55], s73 offen sc1
    s_waitcnt vmcnt(4)
    s_mov_b32 s15, 200000
L_pc_16:
    v_cmp_ne_u32 vcc, s10, v161
    s_cmp_eq_u64 vcc, 0
    s_cbranch_scc1 L_pk_17
    s_sub_u32 s15, s15, 1
    s_cmp_eq_u32 s15, 0
    s_cbranch_scc1 L_pk_17
    s_sleep 8
    buffer_load_dwordx2 v[160:161], v235, s[52:55], 0 offen sc1
    s_waitcnt vmcnt(0)
    s_branch L_pc_16
L_pk_17:
    v_permlane16_swap_b32 v162, v164
    v_permlane16_swap_b32 v163, v165
    v_permlane16_swap_b32 v166, v168
    v_permlane16_swap_b32 v167, v169
    v_and_b32 v46, 0xffff0000, v160
    v_rcp_f32 v46, v46
    v_lshlrev_b32 v160, 16, v160
    v_lshlrev_b32 v16, 16, v162
    v_and_b32 v17, 0xffff0000, v162
    v_lshlrev_b32 v18, 16, v163
    v_and_b32 v19, 0xffff0000, v163
    v_lshlrev_b32 v20, 16, v164
    v_and_b32 v21, 0xffff0000, v164
    v_lshlrev_b32 v22, 16, v165
    v_and_b32 v23, 0xffff0000, v165
    v_lshlrev_b32 v24, 16, v166
    v_and_b32 v25, 0xffff0000, v166
    v_lshlrev_b32 v26, 16, v167
    v_and_b32 v27, 0xffff0000, v167
    v_lshlrev_b32 v28, 16, v168
    v_and_b32 v29, 0xffff0000, v168
    v_lshlrev_b32 v30, 16, v169
    v_and_b32 v31, 0xffff0000, v169
    v_lshlrev_b32 v32, 16, v170
    v_and_b32 v33, 0xffff0000, v170
    v_lshlrev_b32 v34, 16, v171
    v_and_b32 v35, 0xffff0000, v171
    v_pk_add_f32 v[176:177], v[16:17], v[160:161] op_sel_hi:[1,0] neg_lo:[0,1] neg_hi:[0,1]
    v_pk_add_f32 v[178:179], v[18:19], v[160:161] op_sel_hi:[1,0] neg_lo:[0,1] neg_hi:[0,1]
    v_pk_add_f32 v[180:181], v[20:21], v[160:161] op_sel_hi:[1,0] neg_lo:[0,1] neg_hi:[0,1]
    v_pk_add_f32 v[182:183], v[22:23], v[160:161] op_sel_hi:[1,0] neg_lo:[0,1] neg_hi:[0,1]
    v_pk_add_f32 v[184:185], v[24:25], v[160:161] op_sel_hi:[1,0] neg_lo:[0,1] neg_hi:[0,1]
    v_pk_add_f32 v[186:187], v[26:27], v[160:161] op_sel_hi:[1,0] neg_lo:[0,1] neg_hi:[0,1]
    v_pk_add_f32 v[188:189], v[28:29], v[160:161] op_sel_hi:[1,0] neg_lo:[0,1] neg_hi:[0,1]
    v_pk_add_f32 v[190:191], v[30:31], v[160:161] op_sel_hi:[1,0] neg_lo:[0,1] neg_hi:[0,1]
    v_pk_add_f32 v[192:193], v[32:33], v[160:161] op_sel_hi:[1,0] neg_lo:[0,1] neg_hi:[0,1]
    v_pk_add_f32 v[194:195], v[34:35], v[160:161] op_sel_hi:[1,0] neg_lo:[0,1] neg_hi:[0,1]
    v_cvt_pk_bf16_f32 v36, v176, v177
    v_cvt_pk_bf16_f32 v37, v178, v179
    v_cvt_pk_bf16_f32 v38, v180, v181
    v_cvt_pk_bf16_f32 v39, v182, v183
    v_cvt_pk_bf16_f32 v40, v184, v185
    v_cvt_pk_bf16_f32 v41, v186, v187
    v_cvt_pk_bf16_f32 v42, v188, v189
    v_cvt_pk_bf16_f32 v43, v190, v191
    v_cvt_pk_bf16_f32 v44, v192, v193
    v_cvt_pk_bf16_f32 v45, v194, v195
    v_lshlrev_b32 v176, 16, v36
    v_and_b32 v177, 0xffff0000, v36
    v_lshlrev_b32 v178, 16, v37
    v_and_b32 v179, 0xffff0000, v37
    v_lshlrev_b32 v180, 16, v38
    v_and_b32 v181, 0xffff0000, v38
    v_lshlrev_b32 v182, 16, v39
    v_and_b32 v183, 0xffff0000, v39
    v_lshlrev_b32 v184, 16, v40
    v_and_b32 v185, 0xffff0000, v40
    v_lshlrev_b32 v186, 16, v41
    v_and_b32 v187, 0xffff0000, v41
    v_lshlrev_b32 v188, 16, v42
    v_and_b32 v189, 0xffff0000, v42
    v_lshlrev_b32 v190, 16, v43
    v_and_b32 v191, 0xffff0000, v43
    v_lshlrev_b32 v192, 16, v44
    v_and_b32 v193, 0xffff0000, v44
    v_lshlrev_b32 v194, 16, v45
    v_and_b32 v195, 0xffff0000, v45
    v_pk_mul_f32 v[176:177], v[176:177], v[46:47] op_sel_hi:[1,0]
    v_pk_mul_f32 v[178:179], v[178:179], v[46:47] op_sel_hi:[1,0]
    v_pk_mul_f32 v[180:181], v[180:181], v[46:47] op_sel_hi:[1,0]
    v_pk_mul_f32 v[182:183], v[182:183], v[46:47] op_sel_hi:[1,0]
    v_pk_mul_f32 v[184:185], v[184:185], v[46:47] op_sel_hi:[1,0]
    v_pk_mul_f32 v[186:187], v[186:187], v[46:47] op_sel_hi:[1,0]
    v_pk_mul_f32 v[188:189], v[188:189], v[46:47] op_sel_hi:[1,0]
    v_pk_mul_f32 v[190:191], v[190:191], v[46:47] op_sel_hi:[1,0]
    v_pk_mul_f32 v[192:193], v[192:193], v[46:47] op_sel_hi:[1,0]
    v_pk_mul_f32 v[194:195], v[194:195], v[46:47] op_sel_hi:[1,0]
    v_cvt_pk_bf16_f32 v36, v176, v177
    v_cvt_pk_bf16_f32 v37, v178, v179
    v_cvt_pk_bf16_f32 v38, v180, v181
    v_cvt_pk_bf16_f32 v39, v182, v183
    v_cvt_pk_bf16_f32 v40, v184, v185
    v_cvt_pk_bf16_f32 v41, v186, v187
    v_cvt_pk_bf16_f32 v42, v188, v189
    v_cvt_pk_bf16_f32 v43, v190, v191
    v_cvt_pk_bf16_f32 v44, v192, v193
    v_cvt_pk_bf16_f32 v45, v194, v195
    v_lshlrev_b32 v176, 16, v36
    v_and_b32 v177, 0xffff0000, v36
    v_lshlrev_b32 v178, 16, v37
    v_and_b32 v179, 0xffff0000, v37
    v_lshlrev_b32 v180, 16, v38
    v_and_b32 v181, 0xffff0000, v38
    v_lshlrev_b32 v182, 16, v39
    v_and_b32 v183, 0xffff0000, v39
    v_lshlrev_b32 v184, 16, v40
    v_and_b32 v185, 0xffff0000, v40
    v_lshlrev_b32 v186, 16, v41
    v_and_b32 v187, 0xffff0000, v41
    v_lshlrev_b32 v188, 16, v42
    v_and_b32 v189, 0xffff0000, v42
    v_lshlrev_b32 v190, 16, v43
    v_and_b32 v191, 0xffff0000, v43
    v_lshlrev_b32 v192, 16, v44
    v_and_b32 v193, 0xffff0000, v44
    v_lshlrev_b32 v194, 16, v45
    v_and_b32 v195, 0xffff0000, v45
    v_pk_add_f32 v[176:177], v[176:177], v[16:17]
    v_pk_add_f32 v[178:179], v[178:179], v[18:19]
    v_pk_add_f32 v[180:181], v[180:181], v[20:21]
    v_pk_add_f32 v[182:183], v[182:183], v[22:23]
    v_pk_add_f32 v[184:185], v[184:185], v[24:25]
    v_pk_add_f32 v[186:187], v[186:187], v[26:27]
    v_pk_add_f32 v[188:189], v[188:189], v[28:29]
    v_pk_add_f32 v[190:191], v[190:191], v[30:31]
    v_pk_add_f32 v[192:193], v[192:193], v[32:33]
    v_pk_add_f32 v[194:195], v[194:195], v[34:35]
    s_setprio 3
L_nov2:
    s_waitcnt vmcnt(0)
    v_perm_b32 v3, v149, v148, v10
    v_cmp_ne_u32 vcc, s76, v3
    s_cmp_lg_u64 vcc, 0
    s_cbranch_scc1 L_xretry0
L_xok0:
    v_perm_b32 v3, v153, v152, v10
    v_cmp_ne_u32 vcc, s77, v3
    s_cmp_lg_u64 vcc, 0
    s_cbranch_scc1 L_xretry1
L_xok1:
    s_mov_b64 exec, 1
    v_mov_b32 v11, 1
    ds_add_u32 v8, v11 offset:4
    s_mov_b64 exec, -1
    v_and_b32 v148, v9, v148
    v_and_b32 v149, v9, v149
    v_and_b32 v152, v9, v152
    v_and_b32 v153, v9, v153
    v_pk_add_f32 v[132:133], v[132:133], v[148:149]
    v_pk_add_f32 v[144:145], v[144:145], v[152:153]
    s_or_b32 s11, s6, s5
    s_cmp_lg_u32 s11, 0
    s_cbranch_scc1 L_nomask
    v_mov_b32 v3, 0xce6e6b28
    v_cndmask_b32 v132, v3, v132, s[66:67]
    v_cndmask_b32 v133, v3, v133, s[68:69]
    v_cndmask_b32 v136, v3, v136, s[66:67]
    v_cndmask_b32 v137, v3, v137, s[68:69]
    v_cndmask_b32 v140, v3, v140, s[66:67]
    v_cndmask_b32 v141, v3, v141, s[68:69]
    v_cndmask_b32 v144, v3, v144, s[66:67]
    v_cndmask_b32 v145, v3, v145, s[68:69]
L_nomask:
    ds_read_b32 v4, v8 offset:16
    ds_read_b32 v3, v8
    v_max_f32 v88, v132, v133
    v_max_f32 v90, v136, v137
    v_max_f32 v92, v140, v141
    v_max_f32 v94, v144, v145
    s_nop 0
    v_permlane32_swap_b32 v88, v92
    v_permlane32_swap_b32 v90, v94
    v_max_f32 v88, v88, v92
    v_max_f32 v90, v90, v94
    s_nop 1
    v_permlane16_swap_b32 v88, v90
    v_max_f32 v88, v88, v90
    v_mul_f32 v88, v12, v88
    v_mov_b32 v90, v88
    s_nop 1
    v_permlane16_swap_b32 v88, v90
    v_mov_b32 v92, v88
    v_mov_b32 v94, v90
    s_nop 0
    v_permlane32_swap_b32 v88, v92
    v_permlane32_swap_b32 v90, v94
    s_waitcnt lgkmcnt(0)
    v_readfirstlane_b32 s11, v3
    v_readfirstlane_b32 s9, v4
    s_cmp_lt_u32 s11, 4
    s_cbranch_scc1 L_vw
L_vok:
    ds_read_b64_tr_b16 v[48:49], v229 offset:8256
    ds_read_b64_tr_b16 v[50:51], v229 offset:320
    ds_read_b64_tr_b16 v[52:53], v229 offset:8288
    ds_read_b64_tr_b16 v[54:55], v229 offset:352
    ds_read_b64_tr_b16 v[56:57], v229 offset:8320
    ds_read_b64_tr_b16 v[58:59], v229 offset:384
    ds_read_b64_tr_b16 v[60:61], v229 offset:8352
    ds_read_b64_tr_b16 v[62:63], v229 offset:416
    ds_read_b64_tr_b16 v[64:65], v229 offset:8384
    ds_read_b64_tr_b16 v[66:67], v229 offset:448
    v_pk_fma_f32 v[132:133], v[132:133], v[12:13], v[88:89] op_sel_hi:[1,0,0] neg_lo:[0,0,1] neg_hi:[0,0,1]
    v_pk_fma_f32 v[136:137], v[136:137], v[12:13], v[90:91] op_sel_hi:[1,0,0] neg_lo:[0,0,1] neg_hi:[0,0,1]
    v_pk_fma_f32 v[140:141], v[140:141], v[12:13], v[92:93] op_sel_hi:[1,0,0] neg_lo:[0,0,1] neg_hi:[0,0,1]
    v_pk_fma_f32 v[144:145], v[144:145], v[12:13], v[94:95] op_sel_hi:[1,0,0] neg_lo:[0,0,1] neg_hi:[0,0,1]
    v_exp_f32 v132, v132
    v_exp_f32 v133, v133
    v_exp_f32 v136, v136
    v_exp_f32 v137, v137
    v_exp_f32 v140, v140
    v_exp_f32 v141, v141
    v_exp_f32 v144, v144
    v_exp_f32 v145, v145
    v_add_f32 v88, v132, v133
    v_add_f32 v90, v136, v137
    v_add_f32 v92, v140, v141
    v_add_f32 v94, v144, v145
    s_nop 0
    v_permlane32_swap_b32 v88, v92
    v_permlane32_swap_b32 v90, v94
    v_add_f32 v88, v88, v92
    v_add_f32 v90, v90, v94
    s_nop 1
    v_permlane16_swap_b32 v88, v90
    v_add_f32 v88, v88, v90
    v_rcp_f32 v88, v88
    s_nop 0
    v_mov_b32 v90, v88
    s_nop 1
    v_permlane16_swap_b32 v88, v90
    v_mov_b32 v92, v88
    v_mov_b32 v94, v90
    s_nop 0
    v_permlane32_swap_b32 v88, v92
    v_permlane32_swap_b32 v90, v94
    s_waitcnt lgkmcnt(0)
    v_pk_mul_f32 v[132:133], v[132:133], v[88:89] op_sel_hi:[1,0]
    v_pk_mul_f32 v[136:137], v[136:137], v[90:91] op_sel_hi:[1,0]
    v_pk_mul_f32 v[140:141], v[140:141], v[92:93] op_sel_hi:[1,0]
    v_pk_mul_f32 v[144:145], v[144:145], v[94:95] op_sel_hi:[1,0]
    v_cvt_pk_bf16_f32 v134, v132, v132
    v_cvt_pk_bf16_f32 v135, v133, v133
    v_and_b32 v72, v212, v134
    v_and_b32 v73, v213, v135
    v_and_b32 v74, v214, v134
    v_and_b32 v75, v215, v135
    v_cvt_pk_bf16_f32 v138, v136, v136
    v_cvt_pk_bf16_f32 v139, v137, v137
    v_and_b32 v76, v212, v138
    v_and_b32 v77, v213, v139
    v_and_b32 v78, v214, v138
    v_and_b32 v79, v215, v139
    v_mfma_f32_16x16x32_bf16 v[100:103], v[48:51], v[72:75], 0
    v_mfma_f32_16x16x32_bf16 v[104:107], v[52:55], v[72:75], 0
    v_cvt_pk_bf16_f32 v142, v140, v140
    v_cvt_pk_bf16_f32 v143, v141, v141
    v_and_b32 v80, v212, v142
    v_and_b32 v81, v213, v143
    v_and_b32 v82, v214, v142
    v_and_b32 v83, v215, v143
    v_mfma_f32_16x16x32_bf16 v[108:111], v[52:55], v[76:79], 0
    v_mfma_f32_16x16x32_bf16 v[112:115], v[56:59], v[76:79], 0
    v_cvt_pk_bf16_f32 v146, v144, v144
    v_cvt_pk_bf16_f32 v147, v145, v145
    v_and_b32 v84, v212, v146
    v_and_b32 v85, v213, v147
    v_and_b32 v86, v214, v146
    v_and_b32 v87, v215, v147
    v_mfma_f32_16x16x32_bf16 v[116:119], v[56:59], v[80:83], 0
    v_mfma_f32_16x16x32_bf16 v[120:123], v[60:63], v[80:83], 0
    v_mfma_f32_16x16x32_bf16 v[124:127], v[60:63], v[84:87], 0
    v_mfma_f32_16x16x32_bf16 v[128:131], v[64:67], v[84:87], 0
    v_mov_b32 v4, 64
    v_cndmask_b32 v4, v0, v4, s[64:65]
    v_mov_b32 v6, 0x10000
    v_cvt_pk_bf16_f32 v220, v100, v101
    v_cvt_pk_bf16_f32 v221, v102, v103
    v_cvt_pk_bf16_f32 v222, v108, v109
    v_cvt_pk_bf16_f32 v223, v110, v111
    v_cvt_pk_bf16_f32 v224, v116, v117
    v_cvt_pk_bf16_f32 v225, v118, v119
    s_mov_b64 exec, 0xffff
    v_cvt_pk_bf16_f32 v222, v104, v105
    v_cvt_pk_bf16_f32 v223, v106, v107
    s_mov_b32 exec_lo, -1
    v_cvt_pk_bf16_f32 v224, v112, v113
    v_cvt_pk_bf16_f32 v225, v114, v115
    s_mov_b64 exec, -1
    v_cvt_pk_bf16_f32 v226, v124, v125
    v_cvt_pk_bf16_f32 v227, v126, v127
    s_mov_b32 exec_hi, 0xffff
    v_cvt_pk_bf16_f32 v226, v120, v121
    v_cvt_pk_bf16_f32 v227, v122, v123
    s_not_b64 exec, s[28:29]
    v_cvt_pk_bf16_f32 v220, v128, v129
    v_cvt_pk_bf16_f32 v221, v130, v131
    s_mov_b64 exec, -1
    s_and_b32 s11, s31, s9
    s_cbranch_scc1 L_oloc
    buffer_store_dwordx4 v[220:223], v254, s[52:55], s25 offen sc1
    buffer_store_dwordx4 v[224:227], v254, s[52:55], s25 offen offset:1024 sc1
    v_add3_u32 v3, v222, v223, v224
    v_add3_u32 v7, v225, v226, v227
    v_add3_u32 v3, v3, v220, v221
    v_add_u32 v3, v3, v7
    s_nop 1
    v_add_u32_dpp v3, v3, v3 quad_perm:[1,0,3,2] row_mask:0xf bank_mask:0xf
    s_nop 1
    v_add_u32_dpp v3, v3, v3 quad_perm:[2,3,0,1] row_mask:0xf bank_mask:0xf
    v_cndmask_b32 v3, v3, 0, s[64:65]
    v_add_u32 v3, s10, v3
    s_mov_b32 exec_lo, 0x11111113
    s_mov_b32 exec_hi, 0x11111111
    buffer_store_dword v3, v4, s[52:55], s26 offen sc1
    s_branch L_opub
L_oloc:
    buffer_store_dwordx4 v[220:223], v254, s[52:55], s25 offen nt
    buffer_store_dwordx4 v[224:227], v254, s[52:55], s25 offen offset:1024 nt
    v_add3_u32 v3, v222, v223, v224
    v_add3_u32 v7, v225, v226, v227
    v_add3_u32 v3, v3, v220, v221
    v_add_u32 v3, v3, v7
    s_nop 1
    v_add_u32_dpp v3, v3, v3 quad_perm:[1,0,3,2] row_mask:0xf bank_mask:0xf
    s_nop 1
    v_add_u32_dpp v3, v3, v3 quad_perm:[2,3,0,1] row_mask:0xf bank_mask:0xf
    v_cndmask_b32 v3, v3, 0, s[64:65]
    v_add_u32 v3, s10, v3
    s_mov_b32 exec_lo, 0x11111113
    s_mov_b32 exec_hi, 0x11111111
    buffer_store_dword v3, v4, s[52:55], s26 offen nt
L_opub:
    s_mov_b64 exec, 1
    ds_add_u32 v8, v6 offset:4
    s_mov_b64 exec, -1
L_phase2:
    s_setprio 0
    s_cmp_ge_u32 s5, 4
    s_cbranch_scc1 L_nz
    v_mov_b32 v176, 0
    v_mov_b32 v177, 0
    v_mov_b32 v178, 0
    v_mov_b32 v179, 0
    v_mov_b32 v180, 0
    v_mov_b32 v181, 0
    v_mov_b32 v182, 0
    v_mov_b32 v183, 0
    v_mov_b32 v184, 0
    v_mov_b32 v185, 0
    v_mov_b32 v186, 0
    v_mov_b32 v187, 0
    v_mov_b32 v188, 0
    v_mov_b32 v189, 0
    v_mov_b32 v190, 0
    v_mov_b32 v191, 0
    v_mov_b32 v192, 0
    v_mov_b32 v193, 0
    v_mov_b32 v194, 0
    v_mov_b32 v195, 0
L_nz:
    v_mov_b32 v8, 158848
    v_and_b32 v9, 60, v0
    ds_read_b32 v7, v8 offset:4
    s_waitcnt lgkmcnt(0)
    v_readfirstlane_b32 s11, v7
    s_mov_b32 s72, 0
    s_mov_b32 s73, 1
    s_and_b32 s11, s11, 0xff
    s_cmp_lt_u32 s11, 8
    s_cselect_b32 s11, s38, 0
    s_cmp_eq_u32 s11, 3
    s_cbranch_scc1 L_wskip
    s_mov_b32 s73, 0
L_wrd:
    s_mov_b32 s15, 800000
L_wochk:
    ds_read_b32 v7, v8 offset:4
    s_waitcnt lgkmcnt(0)
    v_readfirstlane_b32 s11, v7
    s_and_b32 s11, s11, 0xff
    s_cmp_ge_u32 s11, 8
    s_cbranch_scc1 L_wook
    s_sleep 1
    s_sub_u32 s15, s15, 1
    s_cmp_lg_u32 s15, 0
    s_cbranch_scc1 L_wochk
L_wook:
    ds_read_b64_tr_b16 v[16:17], v244 offset:0
    ds_read_b64_tr_b16 v[18:19], v244 offset:2560
    ds_read_b64_tr_b16 v[20:21], v244 offset:32
    ds_read_b64_tr_b16 v[22:23], v244 offset:2592
    ds_read_b64_tr_b16 v[24:25], v244 offset:64
    ds_read_b64_tr_b16 v[26:27], v244 offset:2624
    ds_read_b64_tr_b16 v[28:29], v244 offset:96
    ds_read_b64_tr_b16 v[30:31], v244 offset:2656
    ds_read_b64_tr_b16 v[32:33], v244 offset:128
    ds_read_b64_tr_b16 v[34:35], v244 offset:2688
    ds_read_b64_tr_b16 v[36:37], v244 offset:5120
    ds_read_b64_tr_b16 v[38:39], v244 offset:7680
    ds_read_b64_tr_b16 v[40:41], v244 offset:5152
    ds_read_b64_tr_b16 v[42:43], v244 offset:7712
    ds_read_b64_tr_b16 v[44:45], v244 offset:5184
    ds_read_b64_tr_b16 v[46:47], v244 offset:7744
    ds_read_b64_tr_b16 v[48:49], v244 offset:5216
    ds_read_b64_tr_b16 v[50:51], v244 offset:7776
    ds_read_b64_tr_b16 v[52:53], v244 offset:5248
    ds_read_b64_tr_b16 v[54:55], v244 offset:7808
    ds_read_b64_tr_b16 v[56:57], v245 offset:9600
    ds_read_b64_tr_b16 v[58:59], v244 offset:12160
    ds_read_b64_tr_b16 v[60:61], v245 offset:9632
    ds_read_b64_tr_b16 v[62:63], v244 offset:12192
    ds_read_b64_tr_b16 v[64:65], v245 offset:9664
    ds_read_b64_tr_b16 v[66:67], v244 offset:12224
    ds_read_b64_tr_b16 v[68:69], v245 offset:9696
    ds_read_b64_tr_b16 v[70:71], v244 offset:12256
    ds_read_b64_tr_b16 v[72:73], v245 offset:9728
    ds_read_b64_tr_b16 v[74:75], v244 offset:12288
    ds_read_b64_tr_b16 v[76:77], v244 offset:14720
    ds_read_b64_tr_b16 v[78:79], v244 offset:17280
    ds_read_b64_tr_b16 v[80:81], v244 offset:14752
    ds_read_b64_tr_b16 v[82:83], v244 offset:17312
    ds_read_b64_tr_b16 v[84:85], v244 offset:14784
    ds_read_b64_tr_b16 v[86:87], v244 offset:17344
    ds_read_b64_tr_b16 v[88:89], v244 offset:14816
    ds_read_b64_tr_b16 v[90:91], v244 offset:17376
    ds_read_b64_tr_b16 v[92:93], v244 offset:14848
    ds_read_b64_tr_b16 v[94:95], v244 offset:17408
    ds_read_b64_tr_b16 v[96:97], v246 offset:19200
    ds_read_b64_tr_b16 v[98:99], v244 offset:21760
    ds_read_b64_tr_b16 v[100:101], v246 offset:19232
    ds_read_b64_tr_b16 v[102:103], v244 offset:21792
    ds_read_b64_tr_b16 v[104:105], v246 offset:19264
    ds_read_b64_tr_b16 v[106:107], v244 offset:21824
    ds_read_b64_tr_b16 v[108:109], v246 offset:19296
    ds_read_b64_tr_b16 v[110:111], v244 offset:21856
    ds_read_b64_tr_b16 v[112:113], v246 offset:19328
    ds_read_b64_tr_b16 v[114:115], v244 offset:21888
    ds_read_b64_tr_b16 v[116:117], v244 offset:24320
    ds_read_b64_tr_b16 v[118:119], v244 offset:26880
    ds_read_b64_tr_b16 v[120:121], v244 offset:24352
    ds_read_b64_tr_b16 v[122:123], v244 offset:26912
    ds_read_b64_tr_b16 v[124:125], v244 offset:24384
    ds_read_b64_tr_b16 v[126:127], v244 offset:26944
    ds_read_b64_tr_b16 v[128:129], v244 offset:24416
    ds_read_b64_tr_b16 v[130:131], v244 offset:26976
    ds_read_b64_tr_b16 v[132:133], v244 offset:24448
    ds_read_b64_tr_b16 v[134:135], v244 offset:27008
    ds_read_b64_tr_b16 v[136:137], v247 offset:28800
    ds_read_b64_tr_b16 v[138:139], v244 offset:31360
    ds_read_b64_tr_b16 v[140:141], v247 offset:28832
    ds_read_b64_tr_b16 v[142:143], v244 offset:31392
    ds_read_b64_tr_b16 v[144:145], v247 offset:28864
    ds_read_b64_tr_b16 v[146:147], v244 offset:31424
    ds_read_b64_tr_b16 v[148:149], v247 offset:28896
    ds_read_b64_tr_b16 v[150:151], v244 offset:31456
    ds_read_b64_tr_b16 v[152:153], v247 offset:28928
    ds_read_b64_tr_b16 v[154:155], v244 offset:31488
    ds_read_b64_tr_b16 v[156:157], v244 offset:33920
    ds_read_b64_tr_b16 v[158:159], v244 offset:36480
    ds_read_b64_tr_b16 v[160:161], v244 offset:33952
    ds_read_b64_tr_b16 v[162:163], v244 offset:36512
    ds_read_b64_tr_b16 v[164:165], v244 offset:33984
    ds_read_b64_tr_b16 v[166:167], v244 offset:36544
    ds_read_b64_tr_b16 v[168:169], v244 offset:34016
    ds_read_b64_tr_b16 v[170:171], v244 offset:36576
    ds_read_b64_tr_b16 v[172:173], v244 offset:34048
    ds_read_b64_tr_b16 v[174:175], v244 offset:36608
    s_mov_b32 s15, 200000
    s_cmp_lg_u32 s73, 0
    s_cbranch_scc1 L_wdone
L_wskip:
    s_cmp_eq_u32 s5, 6
    s_cbranch_scc1 L_selok
L_yret:
    s_mov_b32 s15, 800000
    s_cmp_eq_u32 s38, 0
    s_cbranch_scc1 L_ohint
    s_and_b32 s101, s100, s9
    s_mov_b32 s13, 0x80008
    s_cselect_b32 s13, 0x80010, s13
    s_cselect_b32 s14, 6, 6
    s_cbranch_scc1 L_ow2
    s_cmp_eq_u32 s38, 3
    s_cbranch_scc0 L_ow2
    s_waitcnt vmcnt(0)
    s_mov_b64 exec, 1
    v_mov_b32 v6, 0x100
    ds_add_u32 v8, v6 offset:4
    s_mov_b64 exec, -1
    s_mov_b32 s38, 2
L_ow2:
    ds_read_b32 v3, v8 offset:4
    s_waitcnt lgkmcnt(0)
    v_readfirstlane_b32 s11, v3
    s_bfe_u32 s11, s11, s13
    s_cmp_ge_u32 s11, s14
    s_cbranch_scc1 L_ook
    s_sleep 1
    s_sub_u32 s15, s15, 1
    s_cmp_lg_u32 s15, 0
    s_cbranch_scc1 L_ow2
L_ook:
    s_mov_b32 s15, 200000
L_old0:
    buffer_load_dwordx4 v[196:199], v254, s[52:55], s22 offen offset:0 sc1
    buffer_load_dwordx4 v[200:203], v254, s[52:55], s22 offen offset:1024 sc1
    buffer_load_dword v1, v9, s[52:55], s63 offen offset:0 sc1
L_old1:
    buffer_load_dwordx4 v[204:207], v254, s[52:55], s22 offen offset:2048 sc1
    buffer_load_dwordx4 v[208:211], v254, s[52:55], s22 offen offset:3072 sc1
    buffer_load_dword v2, v9, s[52:55], s63 offen offset:128 sc1
L_old2:
    buffer_load_dwordx4 v[212:215], v254, s[52:55], s23 offen offset:0 sc1
    buffer_load_dwordx4 v[216:219], v254, s[52:55], s23 offen offset:1024 sc1
    buffer_load_dword v4, v9, s[52:55], s63 offen offset:256 sc1
L_old3:
    buffer_load_dwordx4 v[220:223], v254, s[52:55], s23 offen offset:2048 sc1
    buffer_load_dwordx4 v[224:227], v254, s[52:55], s23 offen offset:3072 sc1
    buffer_load_dword v10, v9, s[52:55], s63 offen offset:384 sc1
L_old4:
    buffer_load_dwordx4 v[228:231], v254, s[52:55], s24 offen offset:0 sc1
    buffer_load_dwordx4 v[236:239], v254, s[52:55], s24 offen offset:1024 sc1
    buffer_load_dword v11, v9, s[52:55], s63 offen offset:512 sc1
    s_cmp_eq_u32 s38, 3
    s_cbranch_scc0 L_noack
    s_waitcnt vmcnt(15)
    s_mov_b64 exec, 1
    v_mov_b32 v6, 0x100
    ds_add_u32 v8, v6 offset:4
    s_mov_b64 exec, -1
    s_mov_b32 s38, 2
L_noack:
    s_cmp_lg_u32 s72, 0
    s_cbranch_scc1 L_odisp
    s_cmp_lg_u32 s73, 0
    s_cbranch_scc1 L_wrd
L_wdone:
    s_waitcnt lgkmcnt(0)
    s_waitcnt vmcnt(12)
    v_add3_u32 v3, v196, v197, v198
    v_add3_u32 v5, v199, v200, v201
    v_add3_u32 v3, v3, v202, v203
    v_add_u32 v3, v3, v5
    v_subrev_u32 v5, s10, v1
    s_nop 0
    v_add_u32_dpp v3, v3, v3 quad_perm:[1,0,3,2] row_mask:0xf bank_mask:0xf
    s_nop 0
    s_nop 0
    v_add_u32_dpp v3, v3, v3 quad_perm:[2,3,0,1] row_mask:0xf bank_mask:0xf
    v_cmp_ne_u32 vcc, v3, v5
    s_mov_b32 s72, 1
    s_cmp_lg_u64 vcc, 0
    s_cbranch_scc1 L_oretry
L_ogo0:
    v_mfma_f32_16x16x32_bf16 v[176:179], v[16:19], v[196:199], v[176:179]
    v_mfma_f32_16x16x32_bf16 v[180:183], v[20:23], v[196:199], v[180:183]
    v_mfma_f32_16x16x32_bf16 v[184:187], v[24:27], v[196:199], v[184:187]
    v_mfma_f32_16x16x32_bf16 v[188:191], v[28:31], v[196:199], v[188:191]
    v_mfma_f32_16x16x32_bf16 v[192:195], v[32:35], v[196:199], v[192:195]
    s_waitcnt vmcnt(9)
    v_mfma_f32_16x16x32_bf16 v[176:179], v[36:39], v[200:203], v[176:179]
    v_add3_u32 v3, v204, v205, v206
    ds_read_b64_tr_b16 v[16:17], v244 offset:48640
    ds_read_b64_tr_b16 v[26:27], v244 offset:41024
    v_mfma_f32_16x16x32_bf16 v[180:183], v[40:43], v[200:203], v[180:183]
    v_add3_u32 v5, v207, v208, v209
    ds_read_b64_tr_b16 v[18:19], v244 offset:40960
    ds_read_b64_tr_b16 v[28:29], v244 offset:48736
    v_mfma_f32_16x16x32_bf16 v[184:187], v[44:47], v[200:203], v[184:187]
    v_add3_u32 v3, v3, v210, v211
    v_add_u32 v3, v3, v5
    ds_read_b64_tr_b16 v[20:21], v244 offset:48672
    ds_read_b64_tr_b16 v[30:31], v244 offset:41056
    v_mfma_f32_16x16x32_bf16 v[188:191], v[48:51], v[200:203], v[188:191]
    v_subrev_u32 v5, s10, v2
    v_add_u32_dpp v3, v3, v3 quad_perm:[1,0,3,2] row_mask:0xf bank_mask:0xf
    ds_read_b64_tr_b16 v[22:23], v244 offset:40992
    ds_read_b64_tr_b16 v[32:33], v244 offset:48768
    v_mfma_f32_16x16x32_bf16 v[192:195], v[52:55], v[200:203], v[192:195]
    s_nop 0
    v_add_u32_dpp v3, v3, v3 quad_perm:[2,3,0,1] row_mask:0xf bank_mask:0xf
    v_cmp_ne_u32 vcc, v3, v5
    ds_read_b64_tr_b16 v[24:25], v244 offset:48704
    ds_read_b64_tr_b16 v[34:35], v244 offset:41088
    s_mov_b32 s72, 2
    s_cmp_lg_u64 vcc, 0
    s_cbranch_scc1 L_oretry
L_ogo1:
    v_mfma_f32_16x16x32_bf16 v[176:179], v[56:59], v[204:207], v[176:179]
    ds_read_b64_tr_b16 v[36:37], v244 offset:43520
    ds_read_b64_tr_b16 v[46:47], v244 offset:46144
    v_mfma_f32_16x16x32_bf16 v[180:183], v[60:63], v[204:207], v[180:183]
    ds_read_b64_tr_b16 v[38:39], v244 offset:46080
    ds_read_b64_tr_b16 v[48:49], v244 offset:43616
    v_mfma_f32_16x16x32_bf16 v[184:187], v[64:67], v[204:207], v[184:187]
    ds_read_b64_tr_b16 v[40:41], v244 offset:43552
    ds_read_b64_tr_b16 v[50:51], v244 offset:46176
    v_mfma_f32_16x16x32_bf16 v[188:191], v[68:71], v[204:207], v[188:191]
    ds_read_b64_tr_b16 v[42:43], v244 offset:46112
    ds_read_b64_tr_b16 v[52:53], v244 offset:43648
    v_mfma_f32_16x16x32_bf16 v[192:195], v[72:75], v[204:207], v[192:195]
    ds_read_b64_tr_b16 v[44:45], v244 offset:43584
    ds_read_b64_tr_b16 v[54:55], v244 offset:46208
    s_waitcnt vmcnt(6)
    v_mfma_f32_16x16x32_bf16 v[176:179], v[76:79], v[208:211], v[176:179]
    v_add3_u32 v3, v212, v213, v214
    v_mfma_f32_16x16x32_bf16 v[180:183], v[80:83], v[208:211], v[180:183]
    v_add3_u32 v5, v215, v216, v217
    v_mfma_f32_16x16x32_bf16 v[184:187], v[84:87], v[208:211], v[184:187]
    v_add3_u32 v3, v3, v218, v219
    v_add_u32 v3, v3, v5
    v_mfma_f32_16x16x32_bf16 v[188:191], v[88:91], v[208:211], v[188:191]
    v_subrev_u32 v5, s10, v4
    v_add_u32_dpp v3, v3, v3 quad_perm:[1,0,3,2] row_mask:0xf bank_mask:0xf
    v_mfma_f32_16x16x32_bf16 v[192:195], v[92:95], v[208:211], v[192:195]
    s_nop 0
    v_add_u32_dpp v3, v3, v3 quad_perm:[2,3,0,1] row_mask:0xf bank_mask:0xf
    v_cmp_ne_u32 vcc, v3, v5
    s_mov_b32 s72, 3
    s_cmp_lg_u64 vcc, 0
    s_cbranch_scc1 L_oretry
L_ogo2:
    v_mfma_f32_16x16x32_bf16 v[176:179], v[96:99], v[212:215], v[176:179]
    v_mfma_f32_16x16x32_bf16 v[180:183], v[100:103], v[212:215], v[180:183]
    v_mfma_f32_16x16x32_bf16 v[184:187], v[104:107], v[212:215], v[184:187]
    v_mfma_f32_16x16x32_bf16 v[188:191], v[108:111], v[212:215], v[188:191]
    v_mfma_f32_16x16x32_bf16 v[192:195], v[112:115], v[212:215], v[192:195]
    s_waitcnt vmcnt(3)
    v_mfma_f32_16x16x32_bf16 v[176:179], v[116:119], v[216:219], v[176:179]
    v_add3_u32 v3, v220, v221, v222
    v_mfma_f32_16x16x32_bf16 v[180:183], v[120:123], v[216:219], v[180:183]
    v_add3_u32 v5, v223, v224, v225
    v_mfma_f32_16x16x32_bf16 v[184:187], v[124:127], v[216:219], v[184:187]
    v_add3_u32 v3, v3, v226, v227
    v_add_u32 v3, v3, v5
    v_mfma_f32_16x16x32_bf16 v[188:191], v[128:131], v[216:219], v[188:191]
    v_subrev_u32 v5, s10, v10
    v_add_u32_dpp v3, v3, v3 quad_perm:[1,0,3,2] row_mask:0xf bank_mask:0xf
    v_mfma_f32_16x16x32_bf16 v[192:195], v[132:135], v[216:219], v[192:195]
    s_nop 0
    v_add_u32_dpp v3, v3, v3 quad_perm:[2,3,0,1] row_mask:0xf bank_mask:0xf
    v_cmp_ne_u32 vcc, v3, v5
    s_mov_b32 s72, 4
    s_cmp_lg_u64 vcc, 0
    s_cbranch_scc1 L_oretry
L_ogo3:
    v_mfma_f32_16x16x32_bf16 v[176:179], v[136:139], v[220:223], v[176:179]
    v_mfma_f32_16x16x32_bf16 v[180:183], v[140:143], v[220:223], v[180:183]
    v_mfma_f32_16x16x32_bf16 v[184:187], v[144:147], v[220:223], v[184:187]
    v_mfma_f32_16x16x32_bf16 v[188:191], v[148:151], v[220:223], v[188:191]
    v_mfma_f32_16x16x32_bf16 v[192:195], v[152:155], v[220:223], v[192:195]
    s_waitcnt vmcnt(0)
    v_mfma_f32_16x16x32_bf16 v[176:179], v[156:159], v[224:227], v[176:179]
    v_add3_u32 v3, v228, v229, v230
    v_mfma_f32_16x16x32_bf16 v[180:183], v[160:163], v[224:227], v[180:183]
    v_add3_u32 v5, v231, v236, v237
    v_mfma_f32_16x16x32_bf16 v[184:187], v[164:167], v[224:227], v[184:187]
    v_add3_u32 v3, v3, v238, v239
    v_add_u32 v3, v3, v5
    v_mfma_f32_16x16x32_bf16 v[188:191], v[168:171], v[224:227], v[188:191]
    v_subrev_u32 v5, s10, v11
    v_add_u32_dpp v3, v3, v3 quad_perm:[1,0,3,2] row_mask:0xf bank_mask:0xf
    v_mfma_f32_16x16x32_bf16 v[192:195], v[172:175], v[224:227], v[192:195]
    s_nop 0
    v_add_u32_dpp v3, v3, v3 quad_perm:[2,3,0,1] row_mask:0xf bank_mask:0xf
    v_cmp_ne_u32 vcc, v3, v5
    s_mov_b32 s72, 5
    s_cmp_lg_u64 vcc, 0
    s_cbranch_scc1 L_oretry
L_ogo4:
    s_waitcnt lgkmcnt(0)
    ds_read2_b32 v[6:7], v8 offset0:1 offset1:5
    v_mfma_f32_16x16x32_bf16 v[176:179], v[16:19], v[228:231], v[176:179]
    v_mfma_f32_16x16x32_bf16 v[180:183], v[20:23], v[228:231], v[180:183]
    v_mfma_f32_16x16x32_bf16 v[184:187], v[24:27], v[228:231], v[184:187]
    v_mfma_f32_16x16x32_bf16 v[188:191], v[28:31], v[228:231], v[188:191]
    v_mfma_f32_16x16x32_bf16 v[192:195], v[32:35], v[228:231], v[192:195]
    s_cmp_ge_u32 s5, 4
    s_cbranch_scc1 L_fini
    v_mfma_f32_16x16x32_bf16 v[176:179], v[36:39], v[236:239], v[176:179]
    v_mfma_f32_16x16x32_bf16 v[180:183], v[40:43], v[236:239], v[180:183]
    v_mfma_f32_16x16x32_bf16 v[184:187], v[44:47], v[236:239], v[184:187]
    v_mfma_f32_16x16x32_bf16 v[188:191], v[48:51], v[236:239], v[188:191]
    v_mfma_f32_16x16x32_bf16 v[192:195], v[52:55], v[236:239], v[192:195]
    s_lshl_b32 s11, s5, 3
    s_lshl_b32 s11, 1, s11
    v_mov_b32 v3, s11
    s_nop 0
    ds_write_b128 v232, v[176:179] offset:0
    ds_write_b128 v232, v[180:183] offset:1984
    ds_write_b128 v232, v[184:187] offset:3968
    ds_write_b128 v232, v[188:191] offset:5952
    ds_write_b128 v232, v[192:195] offset:7936
    s_mov_b64 exec, 1
    ds_add_u32 v8, v3 offset:20
    s_mov_b64 exec, -1
    s_branch L_fin
L_fini:
    s_and_b32 s13, s5, 3
    s_lshl_b32 s13, s13, 3
    s_mov_b32 s15, 800000
L_fw:
    s_waitcnt lgkmcnt(0)
    v_readfirstlane_b32 s11, v6
    v_readfirstlane_b32 s12, v7
    s_lshr_b32 s11, s11, 24
    s_lshr_b32 s12, s12, s13
    s_and_b32 s11, s11, s12
    s_bitcmp1_b32 s11, 0
    s_cbranch_scc0 L_fre
L_fok:
    ds_read2_b32 v[6:7], v8 offset0:32 offset1:33
    v_mfma_f32_16x16x32_bf16 v[176:179], v[36:39], v[236:239], v[176:179]
    ds_read_b128 v[56:59], v232 offset:0
    v_mfma_f32_16x16x32_bf16 v[180:183], v[40:43], v[236:239], v[180:183]
    ds_read_b128 v[60:63], v232 offset:1984
    v_mfma_f32_16x16x32_bf16 v[184:187], v[44:47], v[236:239], v[184:187]
    ds_read_b128 v[64:67], v232 offset:3968
    v_mfma_f32_16x16x32_bf16 v[188:191], v[48:51], v[236:239], v[188:191]
    ds_read_b128 v[68:71], v232 offset:5952
    v_mfma_f32_16x16x32_bf16 v[192:195], v[52:55], v[236:239], v[192:195]
    ds_read_b128 v[72:75], v232 offset:7936
    s_waitcnt lgkmcnt(5)
    v_readfirstlane_b32 s76, v6
    v_readfirstlane_b32 s77, v7
    s_lshr_b32 s11, s76, 4
    s_cmp_eq_u32 s11, s60
    s_cbranch_scc1 L_exrow0
L_exb0:
    s_lshr_b32 s11, s77, 4
    s_cmp_eq_u32 s11, s60
    s_cbranch_scc1 L_exrow1
L_exb1:
    s_waitcnt lgkmcnt(0)
    v_pk_add_f32 v[56:57], v[56:57], v[176:177]
    v_cvt_pk_bf16_f32 v80, v56, v57
    v_pk_add_f32 v[58:59], v[58:59], v[178:179]
    v_cvt_pk_bf16_f32 v81, v58, v59
    v_pk_add_f32 v[60:61], v[60:61], v[180:181]
    v_cvt_pk_bf16_f32 v82, v60, v61
    v_pk_add_f32 v[62:63], v[62:63], v[182:183]
    v_cvt_pk_bf16_f32 v83, v62, v63
    v_pk_add_f32 v[64:65], v[64:65], v[184:185]
    v_cvt_pk_bf16_f32 v84, v64, v65
    v_pk_add_f32 v[66:67], v[66:67], v[186:187]
    v_cvt_pk_bf16_f32 v85, v66, v67
    v_permlane16_swap_b32 v80, v82
    v_permlane16_swap_b32 v81, v83
    buffer_store_dwordx4 v[80:83], v233, s[56:59], 0 offen offset:0 nt
    v_pk_add_f32 v[68:69], v[68:69], v[188:189]
    v_cvt_pk_bf16_f32 v86, v68, v69
    v_pk_add_f32 v[70:71], v[70:71], v[190:191]
    v_cvt_pk_bf16_f32 v87, v70, v71
    v_pk_add_f32 v[72:73], v[72:73], v[192:193]
    v_cvt_pk_bf16_f32 v88, v72, v73
    v_pk_add_f32 v[74:75], v[74:75], v[194:195]
    v_cvt_pk_bf16_f32 v89, v74, v75
    v_permlane16_swap_b32 v84, v86
    v_permlane16_swap_b32 v85, v87
    buffer_store_dwordx4 v[84:87], v233, s[56:59], 0 offen offset:64 nt
    buffer_store_dwordx2 v[88:89], v234, s[56:59], 0 offen offset:128 nt
L_fin:
    s_endpgm
L_exrow0:
    v_and_b32 v3, 48, v0
    v_add_u32 v3, 158992, v3
    ds_read_b128 v[96:99], v3 offset:0
    ds_read_b128 v[100:103], v3 offset:64
    ds_read_b128 v[104:107], v3 offset:128
    ds_read_b128 v[108:111], v3 offset:192
    ds_read_b128 v[112:115], v3 offset:256
    v_and_b32 v3, 15, v0
    s_and_b32 s11, s76, 15
    v_cmp_eq_u32 vcc, s11, v3
    s_waitcnt lgkmcnt(0)
    s_mov_b64 exec, vcc
    v_pk_add_f32 v[56:57], v[56:57], v[96:97]
    v_pk_add_f32 v[58:59], v[58:59], v[98:99]
    v_pk_add_f32 v[60:61], v[60:61], v[100:101]
    v_pk_add_f32 v[62:63], v[62:63], v[102:103]
    v_pk_add_f32 v[64:65], v[64:65], v[104:105]
    v_pk_add_f32 v[66:67], v[66:67], v[106:107]
    v_pk_add_f32 v[68:69], v[68:69], v[108:109]
    v_pk_add_f32 v[70:71], v[70:71], v[110:111]
    v_pk_add_f32 v[72:73], v[72:73], v[112:113]
    v_pk_add_f32 v[74:75], v[74:75], v[114:115]
    s_mov_b64 exec, -1
    s_branch L_exb0
L_exrow1:
    v_and_b32 v3, 48, v0
    v_add_u32 v3, 160528, v3
    ds_read_b128 v[96:99], v3 offset:0
    ds_read_b128 v[100:103], v3 offset:64
    ds_read_b128 v[104:107], v3 offset:128
    ds_read_b128 v[108:111], v3 offset:192
    ds_read_b128 v[112:115], v3 offset:256
    v_and_b32 v3, 15, v0
    s_and_b32 s11, s77, 15
    v_cmp_eq_u32 vcc, s11, v3
    s_waitcnt lgkmcnt(0)
    s_mov_b64 exec, vcc
    v_pk_add_f32 v[56:57], v[56:57], v[96:97]
    v_pk_add_f32 v[58:59], v[58:59], v[98:99]
    v_pk_add_f32 v[60:61], v[60:61], v[100:101]
    v_pk_add_f32 v[62:63], v[62:63], v[102:103]
    v_pk_add_f32 v[64:65], v[64:65], v[104:105]
    v_pk_add_f32 v[66:67], v[66:67], v[106:107]
    v_pk_add_f32 v[68:69], v[68:69], v[108:109]
    v_pk_add_f32 v[70:71], v[70:71], v[110:111]
    v_pk_add_f32 v[72:73], v[72:73], v[112:113]
    v_pk_add_f32 v[74:75], v[74:75], v[114:115]
    s_mov_b64 exec, -1
    s_branch L_exb1
L_vw:
    s_mov_b32 s15, 800000
L_vw2:
    ds_read_b32 v3, v8
    s_waitcnt lgkmcnt(0)
    v_readfirstlane_b32 s11, v3
    s_cmp_ge_u32 s11, 4
    s_cbranch_scc1 L_vok
    s_sub_u32 s15, s15, 1
    s_cmp_lg_u32 s15, 0
    s_cbranch_scc1 L_vw2
    s_branch L_vok
L_xretry0:
    s_mov_b32 s15, 0
L_xr0:
    s_add_u32 s15, s15, 1
    s_cmp_ge_u32 s15, 200000
    s_cbranch_scc1 L_xok0
    s_cmp_lt_u32 s15, 48
    s_cbranch_scc1 L_xf0
    s_cmp_lg_u32 s15, 48
    s_cbranch_scc1 L_xs0
    s_lshl_b32 s12, s70, 1
    s_add_u32 s12, s12, 8257536
    v_mov_b32 v134, s10
    buffer_store_dwordx3 v[132:134], v254, s[52:55], s12 offen sc1
L_xs0:
    s_lshl_b32 s12, s72, 1
    s_add_u32 s12, s12, 8257536
    buffer_load_dwordx3 v[148:150], v254, s[52:55], s12 offen sc1
    s_waitcnt vmcnt(0)
    v_cmp_ne_u32 vcc, s10, v150
    s_cmp_eq_u64 vcc, 0
    s_cbranch_scc1 L_xok0
L_xf0:
    buffer_load_dwordx2 v[148:149], v230, s[52:55], s72 offen sc1
    s_waitcnt vmcnt(0)
    v_perm_b32 v3, v149, v148, v10
    v_cmp_ne_u32 vcc, s74, v3
    s_cmp_lg_u64 vcc, 0
    s_cbranch_scc1 L_xr0
    s_branch L_xok0
L_xretry1:
    s_mov_b32 s15, 0
L_xr1:
    s_add_u32 s15, s15, 1
    s_cmp_ge_u32 s15, 200000
    s_cbranch_scc1 L_xok1
    s_cmp_lt_u32 s15, 48
    s_cbranch_scc1 L_xf1
    s_cmp_lg_u32 s15, 48
    s_cbranch_scc1 L_xs1
    s_lshl_b32 s12, s71, 1
    s_add_u32 s12, s12, 8257536
    v_mov_b32 v146, s10
    buffer_store_dwordx3 v[144:146], v254, s[52:55], s12 offen sc1
L_xs1:
    s_lshl_b32 s12, s73, 1
    s_add_u32 s12, s12, 8257536
    buffer_load_dwordx3 v[152:154], v254, s[52:55], s12 offen sc1
    s_waitcnt vmcnt(0)
    v_cmp_ne_u32 vcc, s10, v154
    s_cmp_eq_u64 vcc, 0
    s_cbranch_scc1 L_xok1
L_xf1:
    buffer_load_dwordx2 v[152:153], v230, s[52:55], s73 offen sc1
    s_waitcnt vmcnt(0)
    v_perm_b32 v3, v153, v152, v10
    v_cmp_ne_u32 vcc, s74, v3
    s_cmp_lg_u64 vcc, 0
    s_cbranch_scc1 L_xr1
    s_branch L_xok1
L_oval0:
    s_waitcnt vmcnt(12)
    v_add3_u32 v3, v196, v197, v198
    v_add3_u32 v5, v199, v200, v201
    v_add3_u32 v3, v3, v202, v203
    v_add_u32 v3, v3, v5
    v_subrev_u32 v5, s10, v1
    s_nop 0
    v_add_u32_dpp v3, v3, v3 quad_perm:[1,0,3,2] row_mask:0xf bank_mask:0xf
    s_nop 0
    s_nop 0
    v_add_u32_dpp v3, v3, v3 quad_perm:[2,3,0,1] row_mask:0xf bank_mask:0xf
    v_cmp_ne_u32 vcc, v3, v5
    s_mov_b32 s72, 1
    s_cmp_lg_u64 vcc, 0
    s_cbranch_scc1 L_oretry
    s_branch L_ogo0
L_oval1:
    s_waitcnt vmcnt(9)
    v_add3_u32 v3, v204, v205, v206
    v_add3_u32 v5, v207, v208, v209
    v_add3_u32 v3, v3, v210, v211
    v_add_u32 v3, v3, v5
    v_subrev_u32 v5, s10, v2
    s_nop 0
    v_add_u32_dpp v3, v3, v3 quad_perm:[1,0,3,2] row_mask:0xf bank_mask:0xf
    s_nop 0
    s_nop 0
    v_add_u32_dpp v3, v3, v3 quad_perm:[2,3,0,1] row_mask:0xf bank_mask:0xf
    v_cmp_ne_u32 vcc, v3, v5
    s_mov_b32 s72, 2
    s_cmp_lg_u64 vcc, 0
    s_cbranch_scc1 L_oretry
    s_branch L_ogo1
L_oval2:
    s_waitcnt vmcnt(6)
    v_add3_u32 v3, v212, v213, v214
    v_add3_u32 v5, v215, v216, v217
    v_add3_u32 v3, v3, v218, v219
    v_add_u32 v3, v3, v5
    v_subrev_u32 v5, s10, v4
    s_nop 0
    v_add_u32_dpp v3, v3, v3 quad_perm:[1,0,3,2] row_mask:0xf bank_mask:0xf
    s_nop 0
    s_nop 0
    v_add_u32_dpp v3, v3, v3 quad_perm:[2,3,0,1] row_mask:0xf bank_mask:0xf
    v_cmp_ne_u32 vcc, v3, v5
    s_mov_b32 s72, 3
    s_cmp_lg_u64 vcc, 0
    s_cbranch_scc1 L_oretry
    s_branch L_ogo2
L_oval3:
    s_waitcnt vmcnt(3)
    v_add3_u32 v3, v220, v221, v222
    v_add3_u32 v5, v223, v224, v225
    v_add3_u32 v3, v3, v226, v227
    v_add_u32 v3, v3, v5
    v_subrev_u32 v5, s10, v10
    s_nop 0
    v_add_u32_dpp v3, v3, v3 quad_perm:[1,0,3,2] row_mask:0xf bank_mask:0xf
    s_nop 0
    s_nop 0
    v_add_u32_dpp v3, v3, v3 quad_perm:[2,3,0,1] row_mask:0xf bank_mask:0xf
    v_cmp_ne_u32 vcc, v3, v5
    s_mov_b32 s72, 4
    s_cmp_lg_u64 vcc, 0
    s_cbranch_scc1 L_oretry
    s_branch L_ogo3
L_oval4:
    s_waitcnt vmcnt(0)
    v_add3_u32 v3, v228, v229, v230
    v_add3_u32 v5, v231, v236, v237
    v_add3_u32 v3, v3, v238, v239
    v_add_u32 v3, v3, v5
    v_subrev_u32 v5, s10, v11
    s_nop 0
    v_add_u32_dpp v3, v3, v3 quad_perm:[1,0,3,2] row_mask:0xf bank_mask:0xf
    s_nop 0
    s_nop 0
    v_add_u32_dpp v3, v3, v3 quad_perm:[2,3,0,1] row_mask:0xf bank_mask:0xf
    v_cmp_ne_u32 vcc, v3, v5
    s_mov_b32 s72, 5
    s_cmp_lg_u64 vcc, 0
    s_cbranch_scc1 L_oretry
    s_branch L_ogo4
L_oretry:
    s_waitcnt vmcnt(0)
    s_sub_u32 s15, s15, 1
    s_cmp_eq_u32 s15, 0
    s_cbranch_scc1 L_ogive
    s_sleep 2
    s_cmp_eq_u32 s72, 1
    s_cbranch_scc1 L_old0
    s_cmp_eq_u32 s72, 2
    s_cbranch_scc1 L_old1
    s_cmp_eq_u32 s72, 3
    s_cbranch_scc1 L_old2
    s_cmp_eq_u32 s72, 4
    s_cbranch_scc1 L_old3
    s_cmp_eq_u32 s72, 5
    s_cbranch_scc1 L_old4
L_odisp:
    s_cmp_eq_u32 s72, 1
    s_cbranch_scc1 L_oval0
    s_cmp_eq_u32 s72, 2
    s_cbranch_scc1 L_oval1
    s_cmp_eq_u32 s72, 3
    s_cbranch_scc1 L_oval2
    s_cmp_eq_u32 s72, 4
    s_cbranch_scc1 L_oval3
    s_branch L_oval4
L_ogive:
    s_mov_b32 s15, 1
    s_cmp_eq_u32 s72, 1
    s_cbranch_scc1 L_ogo0
    s_cmp_eq_u32 s72, 2
    s_cbranch_scc1 L_ogo1
    s_cmp_eq_u32 s72, 3
    s_cbranch_scc1 L_ogo2
    s_cmp_eq_u32 s72, 4
    s_cbranch_scc1 L_ogo3
    s_branch L_ogo4
L_ohint:
    v_lshlrev_b32 v3, 7, v0
    s_mov_b64 exec, 31
L_of:
    buffer_load_dword v5, v3, s[52:55], s63 offen offset:64 sc1
    s_waitcnt vmcnt(0)
    v_cmp_ne_u32 vcc, s10, v5
    s_cmp_eq_u64 vcc, 0
    s_cbranch_scc1 L_of2
    s_mov_b64 exec, vcc
    s_sleep 2
    s_sub_u32 s15, s15, 1
    s_cmp_lg_u32 s15, 0
    s_cbranch_scc1 L_of
L_of2:
    s_mov_b64 exec, -1
    s_branch L_ook
L_fre:
    s_sub_u32 s15, s15, 1
    s_cmp_eq_u32 s15, 0
    s_cbranch_scc1 L_fok
    ds_read2_b32 v[6:7], v8 offset0:1 offset1:5
    s_branch L_fw
L_end:
    s_endpgm
.section .rodata,"a"
.p2align 6
.amdhsa_kernel parallel_sum__sliding_local_dilated__moe_arch_mod__prompt_kernel
  .amdhsa_next_free_vgpr 256
  .amdhsa_next_free_sgpr 102
  .amdhsa_accum_offset 256
  .amdhsa_group_segment_fixed_size 0
  .amdhsa_kernarg_size 88
  .amdhsa_user_sgpr_count 2
  .amdhsa_user_sgpr_kernarg_segment_ptr 1
  .amdhsa_system_sgpr_workgroup_id_x 1
  .amdhsa_float_denorm_mode_32 3
.end_amdhsa_kernel
```
